```python
import torch

def _softmax(x, axis=-1):
    return torch.softmax(x, dim=axis)
def _gelu(x):
    return torch.nn.functional.gelu(x, approximate="tanh")
def _silu(x):
    return torch.nn.functional.silu(x)
def _sigmoid(x):
    return torch.sigmoid(x)
def _layernorm(x, axis=-1, eps=1e-5):
    m = x.mean(dim=axis, keepdim=True)
    v = x.var(dim=axis, keepdim=True, unbiased=False)
    return (x - m) / torch.sqrt(v + eps)
def _scatter_add(tgt, idx, src, axis=0):
    return tgt.clone().index_add_(axis, idx, src)
def _segment_sum(src, seg, n):
    out = torch.zeros((n,) + src.shape[1:], dtype=src.dtype)
    return out.index_add_(0, seg, src)
def _pad(x, pw):
    flat = tuple(v for pair in reversed(pw) for v in pair)
    return torch.nn.functional.pad(x, flat)

kernel_name = 'interleave_layers__sliding_local_dilated__mixer_channel_mlp__prompt'

def setup_inputs():

    _w = (lambda a: (lambda t: t.to(torch.bfloat16) if t.is_floating_point() else t)(torch.as_tensor(a)))
    def _A_setup():
        B, S, D = 1, 2048, 448
        return {
            "x": _w((lambda *s: torch.randn(*s, dtype=torch.bfloat16) * 0.05)(B, S, D)),
            "wqkv": _w((lambda *s: torch.randn(*s, dtype=torch.bfloat16) * 0.05)(D, 3 * D)),
            "wo": _w((lambda *s: torch.randn(*s, dtype=torch.bfloat16) * 0.05)(D, D)),
        }
    _A_in = _A_setup()

    def _B_setup():
        B, S, D, F = 1, 2048, 448, 1792
        return {
            "x": _w((lambda *s: torch.randn(*s, dtype=torch.bfloat16) * 0.05)(B, S, D)),
            "w1": _w((lambda *s: torch.randn(*s, dtype=torch.bfloat16) * 1.6)(D, F) * (D ** -0.5)),
            "b1": _w((lambda *s: torch.randn(*s, dtype=torch.bfloat16) * 0.8)(F)),
            "w2": _w((lambda *s: torch.randn(*s, dtype=torch.bfloat16) * 0.2)(F, D) * (F ** -0.5)),
            "b2": _w((lambda *s: torch.randn(*s, dtype=torch.bfloat16) * 0.2)(D)),
        }
    _B_in = _B_setup()

    return {
        "A_x": _A_in["x"],
        "A_wqkv": _A_in["wqkv"],
        "A_wo": _A_in["wo"],
        "B_x": _B_in["x"],
        "B_w1": _B_in["w1"],
        "B_b1": _B_in["b1"],
        "B_w2": _B_in["w2"],
        "B_b2": _B_in["b2"],
    }

def reference(A_x, A_wqkv, A_wo, B_x, B_w1, B_b1, B_w2, B_b2):
    def _A_ref(x, wqkv, wo):
        B, S, D = x.shape
        H = 16; Dh = D // H
        W, dil = 8, 2
        qkv = (lambda x, *d: x.permute(*d))((x @ wqkv).reshape(B, S, 3, H, Dh), 2, 0, 3, 1, 4)
        q, k, v = qkv[0], qkv[1], qkv[2]
        scale = Dh ** -0.5
        pos = torch.arange(S)
        off = torch.arange(W) * dil
        idx = pos[:, None] - off[None, :]
        mask = idx >= 0
        idx_c = torch.where(mask, idx, 0).reshape(-1)
        kg = k[:, :, idx_c, :].reshape(B, H, S, W, Dh)
        vg = v[:, :, idx_c, :].reshape(B, H, S, W, Dh)
        logits = torch.einsum("bhsd,bhswd->bhsw", q, kg) * scale
        logits = torch.where(mask[None, None, :, :], logits, -1e9)
        attn = _softmax(logits, axis=-1)
        o = torch.einsum("bhsw,bhswd->bhsd", attn, vg)
        return (lambda x, *d: x.permute(*d))(o, 0, 2, 1, 3).reshape(B, S, D) @ wo

    def _B_ref(x, w1, b1, w2, b2):
        y = _layernorm(x, axis=-1)
        h = _gelu(torch.einsum("bsd,df->bsf", y, w1) + b1)
        return torch.einsum("bsf,fd->bsd", h, w2) + b2

    x = A_x
    x = x + _A_ref(_layernorm(x, axis=-1), A_wqkv, A_wo)
    x = x + _B_ref(_layernorm(x, axis=-1), B_w1, B_b1, B_w2, B_b2)
    x = x + _A_ref(_layernorm(x, axis=-1), A_wqkv, A_wo)
    x = x + _B_ref(_layernorm(x, axis=-1), B_w1, B_b1, B_w2, B_b2)
    return x
```

```asm
; @launch grid=(256,1,1) block=(256,1,1) lds=163840
.amdgcn_target "amdgcn-amd-amdhsa--gfx950"
.text
.globl interleave_layers__sliding_local_dilated__mixer_channel_mlp__prompt_kernel
.p2align 8
.type interleave_layers__sliding_local_dilated__mixer_channel_mlp__prompt_kernel,@function
interleave_layers__sliding_local_dilated__mixer_channel_mlp__prompt_kernel:
    s_cmp_ge_u32 s2, 256
    s_cbranch_scc1 L_end
    s_load_dwordx16 s[20:35], s[0:1], 0
    s_load_dwordx4 s[36:39], s[0:1], 64
    s_load_dwordx2 s[40:41], s[0:1], 80
    s_getreg_b32 s3, hwreg(HW_REG_XCC_ID, 0, 4)
    s_and_b32 s90, s2, 7
    s_lshr_b32 s91, s2, 3
    s_lshr_b32 s92, s91, 4
    s_lshl_b32 s42, s90, 1
    s_add_u32 s42, s42, s92
    s_and_b32 s43, s91, 15
    s_lshr_b32 s90, s43, 3
    s_lshl_b32 s44, s42, 1
    s_add_u32 s44, s44, s90
    s_and_b32 s45, s43, 7
    s_mov_b32 s99, 0
    v_lshrrev_b32 v2, 6, v0
    v_and_b32 v0, 63, v0
    v_readfirstlane_b32 s46, v2
    v_lshlrev_b32 v1, 4, v0
    v_and_b32 v250, 15, v0
    v_lshrrev_b32 v251, 4, v0
    s_waitcnt lgkmcnt(0)
    s_mov_b32 s4, s40
    s_and_b32 s5, s41, 0xffff
    s_mov_b32 s6, 0x1ee1000
    s_mov_b32 s7, 0x20000
    buffer_load_dword v254, off, s[4:7], 0 sc1
    s_lshl_b32 s40, s46, 14
    s_add_u32 s40, s40, 86016
    s_mov_b32 s8, s20
    s_and_b32 s9, s21, 0xffff
    s_mov_b32 s10, 0x1c0000
    s_mov_b32 s11, 0x20000
    v_mul_u32_u24 v2, 896, v250
    v_lshl_add_u32 v2, v251, 3, v2
    s_lshr_b32 s90, s43, 1
    s_lshl_b32 s91, s42, 3
    s_add_u32 s74, s90, s91
    s_and_b32 s90, s43, 1
    s_mul_i32 s90, s90, 7
    s_add_u32 s75, s90, s46
    s_cmp_lt_u32 s46, 3
    s_cselect_b32 s76, 0, 0x80000000
    s_mul_i32 s90, s74, 14336
    s_lshl_b32 s91, s75, 6
    s_add_u32 s90, s90, s91
    v_or_b32 v3, s76, v2
    buffer_load_dwordx2 v[10:11], v2, s[8:11], s90 offen
    buffer_load_dwordx2 v[12:13], v2, s[8:11], s90 offen offset:32
    buffer_load_dwordx2 v[14:15], v3, s[8:11], s90 offen offset:256
    buffer_load_dwordx2 v[16:17], v3, s[8:11], s90 offen offset:288
    s_mov_b32 s8, s22
    s_and_b32 s9, s23, 0xffff
    s_mov_b32 s10, 0x126000
    s_mov_b32 s11, 0x20000
    s_lshl_b32 s90, s46, 4
    s_add_u32 s90, s90, s42
    s_cmp_lt_u32 s90, 42
    s_cselect_b32 s79, 0, 0x80000000
    s_min_u32 s90, s90, 41
    s_mul_i32 s77, s90, 4682
    s_lshr_b32 s77, s77, 16
    s_mul_i32 s91, s77, 14
    s_sub_u32 s78, s90, s91
    s_mul_i32 s90, s78, 86016
    s_mul_i32 s91, s77, 896
    s_add_u32 s90, s90, s91
    s_mul_i32 s91, s43, 56
    s_add_u32 s90, s90, s91
    v_lshrrev_b32 v4, 2, v0
    v_mul_u32_u24 v4, 2688, v4
    v_and_b32 v5, 3, v0
    v_lshl_add_u32 v4, v5, 4, v4
    v_or_b32 v4, s79, v4
    s_mov_b32 m0, s40
    s_add_u32 s91, s90, 43008
    buffer_load_dwordx4 v4, s[8:11], s90 offen lds
    s_add_u32 m0, s40, 1024
    s_nop 0
    buffer_load_dwordx4 v4, s[8:11], s91 offen lds
    s_mov_b32 s12, s30
    s_and_b32 s13, s31, 0xffff
    s_mov_b32 s14, 0xe00
    s_mov_b32 s15, 0x20000
    s_mov_b32 s16, s36
    s_and_b32 s17, s37, 0xffff
    s_mov_b32 s18, 0x1c0000
    s_mov_b32 s19, 0x20000
    v_bfe_u32 v18, v0, 2, 2
    v_lshl_add_u32 v18, v251, 2, v18
    v_and_b32 v19, 3, v0
    v_lshlrev_b32 v19, 3, v19
    v_lshlrev_b32 v21, 21, v0
    s_mov_b64 exec, 0x1ffff
    buffer_load_dword v253, v21, s[4:7], 0 offen
    s_mov_b64 exec, -1
    s_waitcnt vmcnt(1)
    v_readfirstlane_b32 s1, v254
    s_mov_b32 s90, 0x9E3779B1
    v_mul_lo_u32 v254, v254, s90
    v_add_u32 v254, 0x7F4A7C15, v254
    v_and_b32 v254, -16, v254
    v_lshl_add_u32 v20, v18, 6, v19
    v_add_u32 v20, s40, v20
    ds_read_b64_tr_b16 v[24:25], v20 offset:0
    ds_read_b64_tr_b16 v[26:27], v20 offset:1024
    ds_read_b64_tr_b16 v[28:29], v20 offset:32
    ds_read_b64_tr_b16 v[30:31], v20 offset:1056
    v_readfirstlane_b32 s47, v254
    s_mul_i32 s90, s74, 14
    s_add_u32 s90, s90, s75
    s_lshl_b32 s91, s90, 10
    s_add_u32 s91, s91, 5246976
    v_or_b32 v3, s76, v1
    buffer_store_dwordx4 v[10:13], v1, s[4:7], s91 offen sc1
    s_add_u32 s91, s91, 4096
    buffer_store_dwordx4 v[14:17], v3, s[4:7], s91 offen sc1
    v_cmp_gt_u32 vcc, 12, v250
    s_mul_i32 s91, s43, 84
    s_mul_i32 s92, s77, 28
    s_add_u32 s91, s91, s92
    s_add_u32 s91, s91, s78
    s_lshl_b32 s91, s91, 10
    s_add_u32 s91, s91, 192512
    v_or_b32 v4, s79, v1
    s_waitcnt lgkmcnt(0)
    v_cndmask_b32 v28, 0, v28, vcc
    v_cndmask_b32 v29, 0, v29, vcc
    v_cndmask_b32 v30, 0, v30, vcc
    v_cndmask_b32 v31, 0, v31, vcc
    buffer_store_dwordx4 v[24:27], v4, s[4:7], s91 offen sc1
    s_add_u32 s91, s91, 14336
    buffer_store_dwordx4 v[28:31], v4, s[4:7], s91 offen sc1
    v_mov_b32 v2, 0x3f803f80
    v_mov_b32 v110, 0
    v_mov_b32 v111, 0
    v_dot2_f32_bf16 v110, v10, v2, v110
    v_dot2_f32_bf16 v111, v10, v10, v111
    v_dot2_f32_bf16 v110, v11, v2, v110
    v_dot2_f32_bf16 v111, v11, v11, v111
    v_dot2_f32_bf16 v110, v12, v2, v110
    v_dot2_f32_bf16 v111, v12, v12, v111
    v_dot2_f32_bf16 v110, v13, v2, v110
    v_dot2_f32_bf16 v111, v13, v13, v111
    s_nop 1
    v_mov_b32 v114, v110
    s_nop 1
    v_permlane32_swap_b32 v110, v114
    v_add_f32 v110, v110, v114
    v_mov_b32 v114, v110
    s_nop 1
    v_permlane16_swap_b32 v110, v114
    v_add_f32 v110, v110, v114
    v_mov_b32 v115, v111
    s_nop 1
    v_permlane32_swap_b32 v111, v115
    v_add_f32 v111, v111, v115
    v_mov_b32 v115, v111
    s_nop 1
    v_permlane16_swap_b32 v111, v115
    v_add_f32 v111, v111, v115
    v_mov_b32 v112, 0
    v_mov_b32 v113, 0
    v_dot2_f32_bf16 v112, v14, v2, v112
    v_dot2_f32_bf16 v113, v14, v14, v113
    v_dot2_f32_bf16 v112, v15, v2, v112
    v_dot2_f32_bf16 v113, v15, v15, v113
    v_dot2_f32_bf16 v112, v16, v2, v112
    v_dot2_f32_bf16 v113, v16, v16, v113
    v_dot2_f32_bf16 v112, v17, v2, v112
    v_dot2_f32_bf16 v113, v17, v17, v113
    s_nop 1
    v_mov_b32 v114, v112
    s_nop 1
    v_permlane32_swap_b32 v112, v114
    v_add_f32 v112, v112, v114
    v_mov_b32 v114, v112
    s_nop 1
    v_permlane16_swap_b32 v112, v114
    v_add_f32 v112, v112, v114
    v_mov_b32 v115, v113
    s_nop 1
    v_permlane32_swap_b32 v113, v115
    v_add_f32 v113, v113, v115
    v_mov_b32 v115, v113
    s_nop 1
    v_permlane16_swap_b32 v113, v115
    v_add_f32 v113, v113, v115
    s_lshl_b32 s91, s90, 7
    s_add_u32 s91, s91, 8916992
    v_lshlrev_b32 v2, 3, v250
    v_or_b32 v3, s76, v2
    s_mov_b64 exec, 0xffff
    buffer_store_dwordx2 v[110:111], v2, s[4:7], s91 offen sc1
    buffer_store_dwordx2 v[112:113], v3, s[4:7], s91 offen offset:512 sc1
    s_mov_b64 exec, -1
    s_cmp_eq_u32 s46, 3
    s_cbranch_scc1 L_p2_w1
    s_lshl_b32 s90, s46, 5
    s_add_u32 s90, s90, s44
    s_cmp_lt_u32 s90, 72
    s_cselect_b32 s20, 0, 0x80000000
    s_cmp_eq_u32 s45, 7
    s_cselect_b32 s20, 0x80000000, s20
    s_min_u32 s90, s90, 71
    s_min_u32 s93, s45, 6
    s_cmp_lt_u32 s90, 16
    s_cselect_b32 s8, s24, s32
    s_cselect_b32 s9, s25, s33
    s_mov_b32 s10, 0x188000
    s_cselect_b32 s10, 0x62000, s10
    s_cselect_b32 s91, 28, 32
    s_cselect_b32 s92, 0, 16
    s_mov_b32 s22, 57344
    s_cselect_b32 s22, 16384, s22
    s_mov_b32 s21, 3641344
    s_cselect_b32 s21, 1568768, s21
    s_cselect_b32 s83, 0x80000000, 0
    s_and_b32 s9, s9, 0xffff
    s_mov_b32 s11, 0x20000
    s_sub_u32 s90, s90, s92
    s_lshl_b32 s92, s90, 10
    s_add_u32 s21, s21, s92
    s_lshl_b32 s92, s93, 2
    s_mul_i32 s92, s92, s22
    s_add_u32 s21, s21, s92
    s_mul_i32 s90, s90, s91
    s_mul_i32 s90, s90, 896
    s_lshl_b32 s91, s93, 7
    s_add_u32 s84, s90, s91
    s_mov_b32 s25, 896
    s_mov_b32 s23, 0x80000000
    s_mov_b32 s24, 0
    s_mov_b32 s85, 0
    s_branch L_p2_go
L_p2_w1:
    s_mov_b32 s8, s28
    s_and_b32 s9, s29, 0xffff
    s_mov_b32 s10, 0x188000
    s_mov_b32 s11, 0x20000
    s_lshl_b32 s90, s42, 4
    s_add_u32 s90, s90, s43
    s_cmp_lt_u32 s90, 136
    s_cselect_b32 s23, 0, 0x80000000
    s_mov_b32 s20, 0
    s_mov_b32 s83, 0
    s_mov_b32 s22, 14336
    s_mov_b32 s25, 3584
    s_add_u32 s91, s90, 0
    s_min_u32 s91, s91, 391
    s_mul_i32 s92, s91, 4682
    s_lshr_b32 s92, s92, 16
    s_mul_i32 s93, s92, 14
    s_sub_u32 s91, s91, s93
    s_mul_i32 s84, s91, 114688
    s_lshl_b32 s93, s92, 7
    s_add_u32 s84, s84, s93
    s_mul_i32 s93, s92, 56
    s_add_u32 s93, s93, s91
    s_lshl_b32 s93, s93, 10
    s_add_u32 s21, s93, 2027520
    s_add_u32 s91, s90, 256
    s_min_u32 s91, s91, 391
    s_mul_i32 s92, s91, 4682
    s_lshr_b32 s92, s92, 16
    s_mul_i32 s93, s92, 14
    s_sub_u32 s91, s91, s93
    s_mul_i32 s85, s91, 114688
    s_lshl_b32 s93, s92, 7
    s_add_u32 s85, s85, s93
    s_mul_i32 s93, s92, 56
    s_add_u32 s93, s93, s91
    s_lshl_b32 s93, s93, 10
    s_add_u32 s24, s93, 2027520
L_p2_go:
    v_lshrrev_b32 v6, 3, v0
    v_mul_lo_u32 v6, v6, s25
    v_and_b32 v5, 7, v0
    v_lshl_add_u32 v6, v5, 4, v6
    v_or_b32 v8, s23, v6
    v_or_b32 v6, s20, v6
    v_cmp_lt_u32 vcc, 31, v0
    v_mov_b32 v7, s83
    s_nop 0
    v_cndmask_b32 v7, 0, v7, vcc
    v_or_b32 v7, v7, v6
    s_lshl_b32 s91, s25, 3
    s_add_u32 m0, s40, 2048
    s_nop 0
    buffer_load_dwordx4 v6, s[8:11], s84 offen lds
    s_add_u32 m0, s40, 3072
    s_add_u32 s84, s84, s91
    buffer_load_dwordx4 v6, s[8:11], s84 offen lds
    s_add_u32 m0, s40, 4096
    s_add_u32 s84, s84, s91
    buffer_load_dwordx4 v6, s[8:11], s84 offen lds
    s_add_u32 m0, s40, 5120
    s_add_u32 s84, s84, s91
    buffer_load_dwordx4 v7, s[8:11], s84 offen lds
    s_add_u32 m0, s40, 6144
    s_nop 0
    buffer_load_dwordx4 v8, s[8:11], s85 offen lds
    s_add_u32 m0, s40, 7168
    s_add_u32 s85, s85, s91
    buffer_load_dwordx4 v8, s[8:11], s85 offen lds
    s_add_u32 m0, s40, 8192
    s_add_u32 s85, s85, s91
    buffer_load_dwordx4 v8, s[8:11], s85 offen lds
    s_add_u32 m0, s40, 9216
    s_add_u32 s85, s85, s91
    buffer_load_dwordx4 v8, s[8:11], s85 offen lds
    s_lshl_b32 s90, s74, 5
    s_add_u32 s90, s90, s75
    s_lshl_b32 s90, s90, 2
    s_add_u32 s90, s90, 12288
    v_lshlrev_b32 v2, 4, v0
    v_add_u32 v2, s90, v2
    v_cmp_eq_u32 vcc, 1, v0
    v_mov_b32 v3, s76
    s_nop 0
    v_cndmask_b32 v3, 0, v3, vcc
    v_or_b32 v2, v2, v3
    s_lshl_b32 s90, s43, 6
    s_lshl_b32 s91, s42, 2
    s_add_u32 s90, s90, s91
    s_add_u32 s90, s90, s46
    s_lshl_b32 s90, s90, 2
    s_add_u32 s90, s90, 4096
    v_mov_b32 v3, s90
    v_cmp_eq_u32 vcc, 2, v0
    s_nop 1
    v_cndmask_b32 v2, v2, v3, vcc
    s_lshl_b32 s90, s42, 4
    s_add_u32 s90, s90, s43
    s_lshl_b32 s90, s90, 2
    s_add_u32 s90, s90, 188416
    s_cmp_eq_u32 s46, 0
    s_cselect_b32 s90, s90, 0x80000000
    v_mov_b32 v3, s90
    v_cmp_eq_u32 vcc, 3, v0
    s_nop 1
    v_cndmask_b32 v2, v2, v3, vcc
    v_or_b32 v3, s3, v254
    v_cndmask_b32 v3, v254, v3, vcc
    s_waitcnt vmcnt(8)
    s_mov_b64 exec, 15
    buffer_store_dword v3, v2, s[4:7], 0 offen sc1
    s_mov_b64 exec, -1
    s_getpc_b64 s[96:97]
L_pc:
    s_lshr_b32 s90, s2, 3
    s_lshl_b32 s90, s90, 11
    s_lshl_b32 s91, s46, 9
    s_add_u32 s90, s90, s91
    v_lshlrev_b32 v21, 3, v0
    v_add_u32 v21, s90, v21
    v_min_u32 v21, L_code_end-L_pc-8, v21
    global_load_dwordx2 v[58:59], v21, s[96:97]
    s_waitcnt vmcnt(2)
    v_lshl_add_u32 v20, v18, 7, v19
    v_add_u32 v20, s40, v20
    ds_read_b64_tr_b16 v[24:25], v20 offset:2048
    ds_read_b64_tr_b16 v[26:27], v20 offset:4096
    ds_read_b64_tr_b16 v[28:29], v20 offset:2080
    ds_read_b64_tr_b16 v[30:31], v20 offset:4128
    ds_read_b64_tr_b16 v[32:33], v20 offset:2112
    ds_read_b64_tr_b16 v[34:35], v20 offset:4160
    ds_read_b64_tr_b16 v[36:37], v20 offset:2144
    ds_read_b64_tr_b16 v[38:39], v20 offset:4192
    ds_read_b64_tr_b16 v[40:41], v20 offset:6144
    ds_read_b64_tr_b16 v[42:43], v20 offset:8192
    ds_read_b64_tr_b16 v[44:45], v20 offset:6176
    ds_read_b64_tr_b16 v[46:47], v20 offset:8224
    ds_read_b64_tr_b16 v[48:49], v20 offset:6208
    ds_read_b64_tr_b16 v[50:51], v20 offset:8256
    ds_read_b64_tr_b16 v[52:53], v20 offset:6240
    ds_read_b64_tr_b16 v[54:55], v20 offset:8288
    v_or_b32 v6, s20, v1
    v_or_b32 v8, s23, v1
    s_waitcnt lgkmcnt(8)
    buffer_store_dwordx4 v[24:27], v6, s[4:7], s21 offen sc1
    s_add_u32 s21, s21, s22
    buffer_store_dwordx4 v[28:31], v6, s[4:7], s21 offen sc1
    s_add_u32 s21, s21, s22
    buffer_store_dwordx4 v[32:35], v6, s[4:7], s21 offen sc1
    s_add_u32 s21, s21, s22
    buffer_store_dwordx4 v[36:39], v6, s[4:7], s21 offen sc1
    s_waitcnt lgkmcnt(0)
    buffer_store_dwordx4 v[40:43], v8, s[4:7], s24 offen sc1
    s_add_u32 s24, s24, s22
    buffer_store_dwordx4 v[44:47], v8, s[4:7], s24 offen sc1
    s_add_u32 s24, s24, s22
    buffer_store_dwordx4 v[48:51], v8, s[4:7], s24 offen sc1
    s_add_u32 s24, s24, s22
    buffer_store_dwordx4 v[52:55], v8, s[4:7], s24 offen sc1
    s_lshl_b32 s90, s42, 4
    s_add_u32 s90, s90, s43
    s_lshl_b32 s90, s90, 2
    s_add_u32 s90, s90, 184320
    v_lshlrev_b32 v22, 10, v0
    v_add_u32 v22, s90, v22
    v_cmp_eq_u32 vcc, 1, v0
    v_mov_b32 v23, s23
    s_nop 0
    v_cndmask_b32 v23, 0, v23, vcc
    v_or_b32 v22, v22, v23
    s_cmp_eq_u32 s46, 3
    s_cselect_b32 s90, 0, 0x80000000
    v_or_b32 v22, s90, v22
    v_and_b32 v2, 1, v250
    v_lshlrev_b32 v3, 2, v251
    v_add_u32 v6, 2, v250
    v_add_u32 v4, 0, v3
    v_cmp_eq_u32 vcc, 0, v2
    s_nop 3
    s_mov_b64 s[94:95], vcc
    v_cmp_ge_u32 vcc, v4, v6
    s_nop 3
    s_and_b64 s[50:51], vcc, s[94:95]
    v_cmp_le_u32 vcc, v4, v250
    s_nop 3
    s_and_b64 s[58:59], vcc, s[94:95]
    v_add_u32 v4, 1, v3
    v_cmp_eq_u32 vcc, 1, v2
    s_nop 3
    s_mov_b64 s[94:95], vcc
    v_cmp_ge_u32 vcc, v4, v6
    s_nop 3
    s_and_b64 s[52:53], vcc, s[94:95]
    v_cmp_le_u32 vcc, v4, v250
    s_nop 3
    s_and_b64 s[60:61], vcc, s[94:95]
    v_add_u32 v4, 2, v3
    v_cmp_eq_u32 vcc, 0, v2
    s_nop 3
    s_mov_b64 s[94:95], vcc
    v_cmp_ge_u32 vcc, v4, v6
    s_nop 3
    s_and_b64 s[54:55], vcc, s[94:95]
    v_cmp_le_u32 vcc, v4, v250
    s_nop 3
    s_and_b64 s[62:63], vcc, s[94:95]
    v_add_u32 v4, 3, v3
    v_cmp_eq_u32 vcc, 1, v2
    s_nop 3
    s_mov_b64 s[94:95], vcc
    v_cmp_ge_u32 vcc, v4, v6
    s_nop 3
    s_and_b64 s[56:57], vcc, s[94:95]
    v_cmp_le_u32 vcc, v4, v250
    s_nop 3
    s_and_b64 s[64:65], vcc, s[94:95]
    s_lshl_b32 s90, s42, 3
    s_lshl_b32 s91, s46, 1
    s_add_u32 s98, s90, s91
    s_cmp_eq_u32 s98, 0
    s_cselect_b64 s[66:67], 0, s[50:51]
    s_cselect_b64 s[68:69], 0, s[52:53]
    s_cselect_b64 s[70:71], 0, s[54:55]
    s_cselect_b64 s[72:73], 0, s[56:57]
    s_mov_b32 s48, 0
    s_lshl_b32 s90, s43, 8
    s_add_u32 s90, s90, 4096
    v_lshl_add_u32 v2, v0, 2, s90
    s_mul_i32 s90, s48, 16384
    s_add_u32 s90, s90, 12288
    s_lshl_b32 s91, s98, 7
    s_add_u32 s90, s90, s91
    s_sub_u32 s90, s90, 128
    v_and_b32 v3, 48, v0
    v_add_u32 v3, v3, v0
    v_lshl_add_u32 v3, v3, 2, s90
    s_mov_b32 s94, 0x3fff3fff
    s_mov_b32 s95, 0x3fff
    s_cmp_eq_u32 s98, 0
    s_cselect_b32 s94, 0x3fff0000, s94
    s_lshl_b32 s90, s42, 6
    s_add_u32 s90, s90, 188224
    v_lshl_add_u32 v4, v0, 2, s90
    v_cmp_lt_u32 vcc, 47, v0
    s_nop 1
    v_cndmask_b32 v3, v3, v4, vcc
    v_mov_b32 v5, -1
    v_mov_b32 v6, -16
    v_cndmask_b32 v5, v5, v6, vcc
    s_or_b32 s95, s95, 0xffff0000
    s_mov_b32 s49, 0
L_poll0:
    buffer_load_dword v7, v2, s[4:7], 0 offen sc1
    s_mov_b64 exec, s[94:95]
    buffer_load_dword v8, v3, s[4:7], 0 offen sc1
    s_waitcnt vmcnt(0)
    v_and_b32 v9, v5, v8
    v_cmp_ne_u32 vcc, s47, v9
    s_mov_b64 exec, -1
    s_nop 2
    s_mov_b64 s[96:97], vcc
    v_cmp_ne_u32 vcc, s47, v7
    s_nop 3
    s_or_b64 vcc, vcc, s[96:97]
    s_cbranch_vccz L_poll0_done
    s_add_u32 s49, s49, 1
    s_cmp_lt_u32 s49, 200000
    s_cbranch_scc1 L_poll0
    s_add_u32 s99, s99, 1
L_poll0_done:
    s_mov_b64 exec, 3
    buffer_store_dword v254, v22, s[4:7], 0 offen sc1
    s_mov_b64 exec, -1
    v_and_b32 v9, 15, v8
    v_cmp_ne_u32 vcc, s3, v9
    s_and_b32 s90, vcc_hi, 0xffff0000
    s_cmp_eq_u32 s90, 0
    s_cselect_b32 s101, 1, 0
    v_mov_b32 v4, 0x3f803f80
    v_accvgpr_write_b32 a240, v4
    v_mov_b32 v4, 0x3f803f80
    v_accvgpr_write_b32 a241, v4
    v_mov_b32 v4, 0x3f803f80
    v_accvgpr_write_b32 a242, v4
    v_mov_b32 v4, 0x3f803f80
    v_accvgpr_write_b32 a243, v4
    s_mul_i32 s20, s46, 14336
    s_add_u32 s90, s46, 4
    s_mul_i32 s90, s90, 14336
    s_sub_u32 s91, s46, 2
    s_mul_i32 s91, s91, 14336
    s_add_u32 s91, s91, 1024
    s_cmp_lt_u32 s46, 2
    s_cselect_b32 s21, s90, s91
    s_add_u32 s90, s46, 2
    s_mul_i32 s90, s90, 14336
    s_add_u32 s22, s90, 1024
    s_mul_i32 s23, s43, 86016
    s_add_u32 s23, s23, 192512
    s_mul_i32 s90, s48, 1835008
    s_add_u32 s90, s90, 5246976
    s_mul_i32 s91, s98, 14336
    s_add_u32 s78, s90, s91
    s_add_u32 s82, s78, 14336
    s_add_u32 s79, s78, 4096
    s_add_u32 s80, s78, 8192
    s_add_u32 s81, s78, 12288
    s_add_u32 s83, s82, 4096
    s_add_u32 s84, s82, 8192
    s_add_u32 s85, s82, 12288
    s_lshl_b32 s91, s42, 3
    s_max_u32 s91, s91, 1
    s_sub_u32 s91, s91, 1
    s_mul_i32 s91, s91, 14336
    s_add_u32 s74, s90, s91
    s_lshl_b32 s91, s46, 12
    s_add_u32 s74, s74, s91
    s_add_u32 s75, s91, 86016
    s_add_u32 m0, s20, 0
    s_add_u32 s93, s20, s23
    buffer_load_dwordx4 v1, s[4:7], s93 offen sc1 lds
    s_add_u32 m0, s21, 0
    s_add_u32 s93, s21, s23
    buffer_load_dwordx4 v1, s[4:7], s93 offen sc1 lds
    s_add_u32 m0, s22, 0
    s_add_u32 s93, s22, s23
    buffer_load_dwordx4 v1, s[4:7], s93 offen sc1 lds
    buffer_load_dwordx4 v[114:117], v1, s[4:7], s78 offen offset:0 sc1
    buffer_load_dwordx4 v[118:121], v1, s[4:7], s82 offen offset:0 sc1
    buffer_load_dwordx4 v[122:125], v1, s[4:7], s78 offen offset:1024 sc1
    buffer_load_dwordx4 v[126:129], v1, s[4:7], s82 offen offset:1024 sc1
    s_add_u32 m0, s20, 2048
    s_add_u32 s93, s20, s23
    s_add_u32 s93, s93, 2048
    buffer_load_dwordx4 v1, s[4:7], s93 offen sc1 lds
    s_add_u32 m0, s21, 2048
    s_add_u32 s93, s21, s23
    s_add_u32 s93, s93, 2048
    buffer_load_dwordx4 v1, s[4:7], s93 offen sc1 lds
    s_add_u32 m0, s22, 2048
    s_add_u32 s93, s22, s23
    s_add_u32 s93, s93, 2048
    buffer_load_dwordx4 v1, s[4:7], s93 offen sc1 lds
    s_mov_b32 s27, 0
    s_mov_b32 s25, 0
    s_mul_i32 s90, s48, 229376
    s_add_u32 s90, s90, 8916992
    s_mul_i32 s91, s98, 1792
    s_add_u32 s87, s90, s91
    s_add_u32 s88, s87, 1792
    s_sub_u32 s86, s87, 1792
    s_cmp_eq_u32 s98, 0
    s_cselect_b32 s86, s87, s86
    v_and_b32 v250, 15, v0
    v_lshrrev_b32 v251, 4, v0
    v_lshlrev_b32 v240, 3, v250
    v_lshl_add_u32 v240, v251, 7, v240
    v_mov_b32 v242, 0x80000000
    v_cmp_lt_u32 vcc, 1, v251
    s_nop 1
    v_cndmask_b32 v241, 0, v242, vcc
    v_or_b32 v241, v241, v240
    v_add_u32 v243, 57344, v1
    v_lshlrev_b32 v244, 4, v251
    v_add_u32 v244, 151552, v244
    v_lshlrev_b32 v245, 2, v250
    v_add_u32 v245, 151552, v245
    s_mul_i32 s90, s46, 384
    s_add_u32 s90, s90, 153088
    v_lshl_add_u32 v162, v250, 2, s90
    v_lshl_add_u32 v163, v251, 4, s90
    s_lshl_b32 s90, s45, 7
    s_add_u32 s90, s90, 8192
    v_lshl_add_u32 v248, v0, 2, s90
    s_lshr_b32 s91, s46, 1
    s_lshl_b32 s92, s44, 2
    s_add_u32 s91, s91, s92
    s_lshl_b32 s91, s91, 5
    s_and_b32 s90, s46, 1
    s_add_u32 s91, s91, s90
    s_min_u32 s90, s45, 6
    s_lshl_b32 s90, s90, 1
    s_add_u32 s91, s91, s90
    s_lshl_b32 s91, s91, 2
    s_add_u32 s91, s91, 4096
    v_lshl_add_u32 v249, v0, 8, s91
    v_cmp_lt_u32 vcc, 31, v0
    s_nop 1
    v_cndmask_b32 v248, v248, v249, vcc
    s_lshr_b32 s90, s43, 3
    s_mul_i32 s90, s90, 7
    s_min_u32 s91, s45, 6
    s_add_u32 s90, s90, s91
    s_mul_i32 s90, s90, 112
    s_add_u32 s90, s90, 184184
    v_lshl_add_u32 v249, v0, 2, s90
    v_cmp_lt_u32 vcc, 33, v0
    s_nop 1
    v_cndmask_b32 v248, v248, v249, vcc
    s_lshl_b32 s90, s42, 7
    s_add_u32 s90, s90, 176128
    v_and_b32 v247, 15, v0
    v_lshl_add_u32 v247, v247, 2, s90
    s_lshl_b32 s91, s98, 7
    s_add_u32 s91, s91, 28544
    v_lshl_add_u32 v253, v0, 2, s91
    s_cmp_eq_u32 s46, 0
    s_cselect_b32 s90, 0, 16
    v_cmp_gt_u32 vcc, s90, v0
    s_nop 1
    v_cndmask_b32 v247, v247, v253, vcc
    s_mov_b32 s30, 0x3fff3fff
    s_mov_b32 s31, 0
    s_cmp_eq_u32 s42, 0
    s_cselect_b32 s30, 0x3fff, s30
    v_and_b32 v253, 15, v0
    v_lshlrev_b32 v253, 2, v253
    v_add_u32 v253, 28672, v253
    s_cmp_eq_u32 s98, 0
    s_cselect_b64 vcc, -1, 0
    v_cndmask_b32 v247, v247, v253, vcc
    s_mul_i32 s90, s46, 14336
    v_add_u32 v252, s90, v1
    s_and_b32 s90, s46, 1
    s_mul_i32 s90, s90, 14336
    v_add_u32 v242, s90, v243
    s_waitcnt vmcnt(7)
    s_barrier
    s_lshl_b32 s90, s45, 5
    s_add_u32 s90, s90, s44
    s_lshl_b32 s90, s90, 2
    s_add_u32 s90, s90, 8192
    s_cmp_eq_u32 s46, 0
    s_cselect_b32 s90, s90, 0x80000000
    v_mov_b32 v2, s90
    s_mov_b64 exec, 1
    buffer_store_dword v254, v2, s[4:7], 0 offen sc1
    s_mov_b64 exec, -1
    ds_read_b128 v[66:69], v1 offset:0
    ds_read_b128 v[70:73], v1 offset:14336
    ds_read_b128 v[74:77], v1 offset:28672
    ds_read_b128 v[78:81], v1 offset:43008
    ds_read_b128 v[82:85], v243 offset:0
    ds_read_b128 v[86:89], v243 offset:14336
    s_waitcnt vmcnt(5)
    s_waitcnt lgkmcnt(0)
    ds_read_b128 v[186:189], v252 offset:0
    ds_read_b128 v[190:193], v242 offset:0
    v_mfma_f32_16x16x32_bf16 v[2:5], v[66:69], v[114:117], 0
    ds_read_b128 v[90:93], v1 offset:1024
    v_mfma_f32_16x16x32_bf16 v[6:9], v[70:73], v[114:117], 0
    ds_read_b128 v[94:97], v1 offset:15360
    v_mfma_f32_16x16x32_bf16 v[10:13], v[66:69], v[118:121], 0
    ds_read_b128 v[98:101], v1 offset:29696
    v_mfma_f32_16x16x32_bf16 v[14:17], v[70:73], v[118:121], 0
    ds_read_b128 v[102:105], v1 offset:44032
    v_mfma_f32_16x16x32_bf16 v[18:21], v[74:77], v[114:117], 0
    ds_read_b128 v[106:109], v243 offset:1024
    v_mfma_f32_16x16x32_bf16 v[22:25], v[78:81], v[114:117], 0
    ds_read_b128 v[110:113], v243 offset:15360
    v_mfma_f32_16x16x32_bf16 v[26:29], v[74:77], v[118:121], 0
    buffer_load_dwordx4 v[130:133], v1, s[4:7], s78 offen offset:2048 sc1
    v_mfma_f32_16x16x32_bf16 v[30:33], v[78:81], v[118:121], 0
    s_add_u32 m0, s20, 4096
    s_add_u32 s93, s20, s23
    s_add_u32 s93, s93, 4096
    buffer_load_dwordx4 v1, s[4:7], s93 offen sc1 lds
    v_mfma_f32_16x16x32_bf16 v[34:37], v[114:117], v[82:85], 0
    buffer_load_dwordx4 v[134:137], v1, s[4:7], s82 offen offset:2048 sc1
    v_mfma_f32_16x16x32_bf16 v[38:41], v[114:117], v[86:89], 0
    s_add_u32 m0, s21, 4096
    s_add_u32 s93, s21, s23
    s_add_u32 s93, s93, 4096
    buffer_load_dwordx4 v1, s[4:7], s93 offen sc1 lds
    v_mfma_f32_16x16x32_bf16 v[42:45], v[118:121], v[82:85], 0
    buffer_load_dwordx4 v[138:141], v1, s[4:7], s78 offen offset:3072 sc1
    v_mfma_f32_16x16x32_bf16 v[46:49], v[118:121], v[86:89], 0
    s_waitcnt lgkmcnt(6)
    s_add_u32 m0, s22, 4096
    s_add_u32 s93, s22, s23
    s_add_u32 s93, s93, 4096
    buffer_load_dwordx4 v1, s[4:7], s93 offen sc1 lds
    v_mfma_f32_16x16x32_bf16 v[194:197], v[186:189], a[240:243], 0
    buffer_load_dwordx4 v[142:145], v1, s[4:7], s82 offen offset:3072 sc1
    s_add_u32 m0, s20, 6144
    s_add_u32 s93, s20, s23
    s_add_u32 s93, s93, 6144
    buffer_load_dwordx4 v1, s[4:7], s93 offen sc1 lds
    v_mfma_f32_16x16x32_bf16 v[198:201], a[240:243], v[190:193], 0
    s_add_u32 m0, s21, 6144
    s_add_u32 s93, s21, s23
    s_add_u32 s93, s93, 6144
    buffer_load_dwordx4 v1, s[4:7], s93 offen sc1 lds
    s_add_u32 m0, s22, 6144
    s_add_u32 s93, s22, s23
    s_add_u32 s93, s93, 6144
    buffer_load_dwordx4 v1, s[4:7], s93 offen sc1 lds
    s_waitcnt vmcnt(13)
    s_waitcnt lgkmcnt(0)
    ds_read_b128 v[186:189], v252 offset:1024
    ds_read_b128 v[190:193], v242 offset:1024
    v_mfma_f32_16x16x32_bf16 v[2:5], v[90:93], v[122:125], v[2:5]
    v_mfma_f32_16x16x32_bf16 v[6:9], v[94:97], v[122:125], v[6:9]
    v_mfma_f32_16x16x32_bf16 v[10:13], v[90:93], v[126:129], v[10:13]
    s_waitcnt vmcnt(10)
    s_barrier
    v_mfma_f32_16x16x32_bf16 v[14:17], v[94:97], v[126:129], v[14:17]
    ds_read_b128 v[66:69], v1 offset:2048
    v_mfma_f32_16x16x32_bf16 v[18:21], v[98:101], v[122:125], v[18:21]
    ds_read_b128 v[70:73], v1 offset:16384
    v_mfma_f32_16x16x32_bf16 v[22:25], v[102:105], v[122:125], v[22:25]
    ds_read_b128 v[74:77], v1 offset:30720
    v_mfma_f32_16x16x32_bf16 v[26:29], v[98:101], v[126:129], v[26:29]
    ds_read_b128 v[78:81], v1 offset:45056
    buffer_load_dwordx4 v[146:149], v1, s[4:7], s79 offen offset:0 sc1
    v_mfma_f32_16x16x32_bf16 v[30:33], v[102:105], v[126:129], v[30:33]
    ds_read_b128 v[82:85], v243 offset:2048
    v_mfma_f32_16x16x32_bf16 v[34:37], v[122:125], v[106:109], v[34:37]
    ds_read_b128 v[86:89], v243 offset:16384
    buffer_load_dwordx4 v[150:153], v1, s[4:7], s83 offen offset:0 sc1
    v_mfma_f32_16x16x32_bf16 v[38:41], v[122:125], v[110:113], v[38:41]
    v_mfma_f32_16x16x32_bf16 v[42:45], v[126:129], v[106:109], v[42:45]
    buffer_load_dwordx4 v[154:157], v1, s[4:7], s79 offen offset:1024 sc1
    v_mfma_f32_16x16x32_bf16 v[46:49], v[126:129], v[110:113], v[46:49]
    s_waitcnt lgkmcnt(6)
    v_mfma_f32_16x16x32_bf16 v[194:197], v[186:189], a[240:243], v[194:197]
    buffer_load_dwordx4 v[158:161], v1, s[4:7], s83 offen offset:1024 sc1
    v_mfma_f32_16x16x32_bf16 v[198:201], a[240:243], v[190:193], v[198:201]
    s_waitcnt vmcnt(11)
    s_waitcnt lgkmcnt(0)
    ds_read_b128 v[186:189], v252 offset:2048
    ds_read_b128 v[190:193], v242 offset:2048
    v_mfma_f32_16x16x32_bf16 v[2:5], v[66:69], v[130:133], v[2:5]
    ds_read_b128 v[90:93], v1 offset:3072
    v_mfma_f32_16x16x32_bf16 v[6:9], v[70:73], v[130:133], v[6:9]
    ds_read_b128 v[94:97], v1 offset:17408
    v_mfma_f32_16x16x32_bf16 v[10:13], v[66:69], v[134:137], v[10:13]
    ds_read_b128 v[98:101], v1 offset:31744
    v_mfma_f32_16x16x32_bf16 v[14:17], v[70:73], v[134:137], v[14:17]
    ds_read_b128 v[102:105], v1 offset:46080
    v_mfma_f32_16x16x32_bf16 v[18:21], v[74:77], v[130:133], v[18:21]
    ds_read_b128 v[106:109], v243 offset:3072
    v_mfma_f32_16x16x32_bf16 v[22:25], v[78:81], v[130:133], v[22:25]
    ds_read_b128 v[110:113], v243 offset:17408
    v_mfma_f32_16x16x32_bf16 v[26:29], v[74:77], v[134:137], v[26:29]
    buffer_load_dwordx4 v[114:117], v1, s[4:7], s79 offen offset:2048 sc1
    v_mfma_f32_16x16x32_bf16 v[30:33], v[78:81], v[134:137], v[30:33]
    s_add_u32 m0, s20, 8192
    s_add_u32 s93, s20, s23
    s_add_u32 s93, s93, 8192
    buffer_load_dwordx4 v1, s[4:7], s93 offen sc1 lds
    v_mfma_f32_16x16x32_bf16 v[34:37], v[130:133], v[82:85], v[34:37]
    buffer_load_dwordx2 v[218:219], v240, s[4:7], s87 offen offset:0 sc1
    v_mfma_f32_16x16x32_bf16 v[38:41], v[130:133], v[86:89], v[38:41]
    buffer_load_dwordx4 v[118:121], v1, s[4:7], s83 offen offset:2048 sc1
    v_mfma_f32_16x16x32_bf16 v[42:45], v[134:137], v[82:85], v[42:45]
    s_add_u32 m0, s21, 8192
    s_add_u32 s93, s21, s23
    s_add_u32 s93, s93, 8192
    buffer_load_dwordx4 v1, s[4:7], s93 offen sc1 lds
    v_mfma_f32_16x16x32_bf16 v[46:49], v[134:137], v[86:89], v[46:49]
    s_waitcnt lgkmcnt(6)
    buffer_load_dwordx2 v[220:221], v240, s[4:7], s87 offen offset:512 sc1
    v_mfma_f32_16x16x32_bf16 v[194:197], v[186:189], a[240:243], v[194:197]
    s_add_u32 m0, s22, 8192
    s_add_u32 s93, s22, s23
    s_add_u32 s93, s93, 8192
    buffer_load_dwordx4 v1, s[4:7], s93 offen sc1 lds
    v_mfma_f32_16x16x32_bf16 v[198:201], a[240:243], v[190:193], v[198:201]
    s_waitcnt vmcnt(14)
    s_waitcnt lgkmcnt(0)
    ds_read_b128 v[186:189], v252 offset:3072
    ds_read_b128 v[190:193], v242 offset:3072
    v_mfma_f32_16x16x32_bf16 v[2:5], v[90:93], v[138:141], v[2:5]
    v_mfma_f32_16x16x32_bf16 v[6:9], v[94:97], v[138:141], v[6:9]
    v_mfma_f32_16x16x32_bf16 v[10:13], v[90:93], v[142:145], v[10:13]
    s_waitcnt vmcnt(15)
    s_barrier
    v_mfma_f32_16x16x32_bf16 v[14:17], v[94:97], v[142:145], v[14:17]
    ds_read_b128 v[66:69], v1 offset:4096
    v_mfma_f32_16x16x32_bf16 v[18:21], v[98:101], v[138:141], v[18:21]
    ds_read_b128 v[70:73], v1 offset:18432
    v_mfma_f32_16x16x32_bf16 v[22:25], v[102:105], v[138:141], v[22:25]
    ds_read_b128 v[74:77], v1 offset:32768
    v_mfma_f32_16x16x32_bf16 v[26:29], v[98:101], v[142:145], v[26:29]
    ds_read_b128 v[78:81], v1 offset:47104
    buffer_load_dwordx4 v[122:125], v1, s[4:7], s79 offen offset:3072 sc1
    v_mfma_f32_16x16x32_bf16 v[30:33], v[102:105], v[142:145], v[30:33]
    ds_read_b128 v[82:85], v243 offset:4096
    v_mfma_f32_16x16x32_bf16 v[34:37], v[138:141], v[106:109], v[34:37]
    ds_read_b128 v[86:89], v243 offset:18432
    buffer_load_dwordx2 v[222:223], v240, s[4:7], s87 offen offset:1024 sc1
    v_mfma_f32_16x16x32_bf16 v[38:41], v[138:141], v[110:113], v[38:41]
    buffer_load_dwordx4 v[126:129], v1, s[4:7], s83 offen offset:3072 sc1
    v_mfma_f32_16x16x32_bf16 v[42:45], v[142:145], v[106:109], v[42:45]
    v_mfma_f32_16x16x32_bf16 v[46:49], v[142:145], v[110:113], v[46:49]
    s_waitcnt lgkmcnt(6)
    buffer_load_dwordx2 v[224:225], v241, s[4:7], s87 offen offset:1536 sc1
    v_mfma_f32_16x16x32_bf16 v[194:197], v[186:189], a[240:243], v[194:197]
    v_mfma_f32_16x16x32_bf16 v[198:201], a[240:243], v[190:193], v[198:201]
    s_waitcnt vmcnt(13)
    s_waitcnt lgkmcnt(0)
    ds_read_b128 v[186:189], v252 offset:4096
    ds_read_b128 v[190:193], v242 offset:4096
    v_mfma_f32_16x16x32_bf16 v[2:5], v[66:69], v[146:149], v[2:5]
    ds_read_b128 v[90:93], v1 offset:5120
    v_mfma_f32_16x16x32_bf16 v[6:9], v[70:73], v[146:149], v[6:9]
    ds_read_b128 v[94:97], v1 offset:19456
    v_mfma_f32_16x16x32_bf16 v[10:13], v[66:69], v[150:153], v[10:13]
    ds_read_b128 v[98:101], v1 offset:33792
    v_mfma_f32_16x16x32_bf16 v[14:17], v[70:73], v[150:153], v[14:17]
    ds_read_b128 v[102:105], v1 offset:48128
    v_mfma_f32_16x16x32_bf16 v[18:21], v[74:77], v[146:149], v[18:21]
    ds_read_b128 v[106:109], v243 offset:5120
    v_mfma_f32_16x16x32_bf16 v[22:25], v[78:81], v[146:149], v[22:25]
    ds_read_b128 v[110:113], v243 offset:19456
    v_mfma_f32_16x16x32_bf16 v[26:29], v[74:77], v[150:153], v[26:29]
    buffer_load_dwordx4 v[130:133], v1, s[4:7], s80 offen offset:0 sc1
    v_mfma_f32_16x16x32_bf16 v[30:33], v[78:81], v[150:153], v[30:33]
    s_add_u32 m0, s20, 10240
    s_add_u32 s93, s20, s23
    s_add_u32 s93, s93, 10240
    buffer_load_dwordx4 v1, s[4:7], s93 offen sc1 lds
    v_mfma_f32_16x16x32_bf16 v[34:37], v[146:149], v[82:85], v[34:37]
    buffer_load_dwordx2 v[226:227], v240, s[4:7], s88 offen offset:0 sc1
    v_mfma_f32_16x16x32_bf16 v[38:41], v[146:149], v[86:89], v[38:41]
    buffer_load_dwordx4 v[134:137], v1, s[4:7], s84 offen offset:0 sc1
    v_mfma_f32_16x16x32_bf16 v[42:45], v[150:153], v[82:85], v[42:45]
    s_add_u32 m0, s21, 10240
    s_add_u32 s93, s21, s23
    s_add_u32 s93, s93, 10240
    buffer_load_dwordx4 v1, s[4:7], s93 offen sc1 lds
    v_mfma_f32_16x16x32_bf16 v[46:49], v[150:153], v[86:89], v[46:49]
    s_waitcnt lgkmcnt(6)
    buffer_load_dwordx2 v[228:229], v240, s[4:7], s88 offen offset:512 sc1
    v_mfma_f32_16x16x32_bf16 v[194:197], v[186:189], a[240:243], v[194:197]
    s_add_u32 m0, s22, 10240
    s_add_u32 s93, s22, s23
    s_add_u32 s93, s93, 10240
    buffer_load_dwordx4 v1, s[4:7], s93 offen sc1 lds
    v_mfma_f32_16x16x32_bf16 v[198:201], a[240:243], v[190:193], v[198:201]
    s_waitcnt vmcnt(18)
    s_waitcnt lgkmcnt(0)
    ds_read_b128 v[186:189], v252 offset:5120
    ds_read_b128 v[190:193], v242 offset:5120
    v_mfma_f32_16x16x32_bf16 v[2:5], v[90:93], v[154:157], v[2:5]
    v_mfma_f32_16x16x32_bf16 v[6:9], v[94:97], v[154:157], v[6:9]
    v_mfma_f32_16x16x32_bf16 v[10:13], v[90:93], v[158:161], v[10:13]
    s_waitcnt vmcnt(22)
    s_barrier
    v_mfma_f32_16x16x32_bf16 v[14:17], v[94:97], v[158:161], v[14:17]
    ds_read_b128 v[66:69], v1 offset:6144
    v_mfma_f32_16x16x32_bf16 v[18:21], v[98:101], v[154:157], v[18:21]
    ds_read_b128 v[70:73], v1 offset:20480
    v_mfma_f32_16x16x32_bf16 v[22:25], v[102:105], v[154:157], v[22:25]
    ds_read_b128 v[74:77], v1 offset:34816
    v_mfma_f32_16x16x32_bf16 v[26:29], v[98:101], v[158:161], v[26:29]
    ds_read_b128 v[78:81], v1 offset:49152
    buffer_load_dwordx4 v[138:141], v1, s[4:7], s80 offen offset:1024 sc1
    v_mfma_f32_16x16x32_bf16 v[30:33], v[102:105], v[158:161], v[30:33]
    ds_read_b128 v[82:85], v243 offset:6144
    v_mfma_f32_16x16x32_bf16 v[34:37], v[154:157], v[106:109], v[34:37]
    ds_read_b128 v[86:89], v243 offset:20480
    buffer_load_dwordx2 v[230:231], v240, s[4:7], s88 offen offset:1024 sc1
    v_mfma_f32_16x16x32_bf16 v[38:41], v[154:157], v[110:113], v[38:41]
    buffer_load_dwordx4 v[142:145], v1, s[4:7], s84 offen offset:1024 sc1
    v_mfma_f32_16x16x32_bf16 v[42:45], v[158:161], v[106:109], v[42:45]
    v_mfma_f32_16x16x32_bf16 v[46:49], v[158:161], v[110:113], v[46:49]
    s_waitcnt lgkmcnt(6)
    buffer_load_dwordx2 v[232:233], v241, s[4:7], s88 offen offset:1536 sc1
    v_mfma_f32_16x16x32_bf16 v[194:197], v[186:189], a[240:243], v[194:197]
    v_mfma_f32_16x16x32_bf16 v[198:201], a[240:243], v[190:193], v[198:201]
    s_waitcnt vmcnt(18)
    s_waitcnt lgkmcnt(0)
    ds_read_b128 v[186:189], v252 offset:6144
    ds_read_b128 v[190:193], v242 offset:6144
    v_mfma_f32_16x16x32_bf16 v[2:5], v[66:69], v[114:117], v[2:5]
    ds_read_b128 v[90:93], v1 offset:7168
    v_mfma_f32_16x16x32_bf16 v[6:9], v[70:73], v[114:117], v[6:9]
    ds_read_b128 v[94:97], v1 offset:21504
    v_mfma_f32_16x16x32_bf16 v[10:13], v[66:69], v[118:121], v[10:13]
    ds_read_b128 v[98:101], v1 offset:35840
    v_mfma_f32_16x16x32_bf16 v[14:17], v[70:73], v[118:121], v[14:17]
    ds_read_b128 v[102:105], v1 offset:50176
    v_mfma_f32_16x16x32_bf16 v[18:21], v[74:77], v[114:117], v[18:21]
    ds_read_b128 v[106:109], v243 offset:7168
    v_mfma_f32_16x16x32_bf16 v[22:25], v[78:81], v[114:117], v[22:25]
    ds_read_b128 v[110:113], v243 offset:21504
    v_mfma_f32_16x16x32_bf16 v[26:29], v[74:77], v[118:121], v[26:29]
    buffer_load_dwordx4 v[146:149], v1, s[4:7], s80 offen offset:2048 sc1
    v_mfma_f32_16x16x32_bf16 v[30:33], v[78:81], v[118:121], v[30:33]
    s_add_u32 m0, s20, 12288
    s_add_u32 s93, s20, s23
    s_add_u32 s93, s93, 12288
    buffer_load_dwordx4 v1, s[4:7], s93 offen sc1 lds
    v_mfma_f32_16x16x32_bf16 v[34:37], v[114:117], v[82:85], v[34:37]
    v_mfma_f32_16x16x32_bf16 v[38:41], v[114:117], v[86:89], v[38:41]
    buffer_load_dwordx4 v[150:153], v1, s[4:7], s84 offen offset:2048 sc1
    v_mfma_f32_16x16x32_bf16 v[42:45], v[118:121], v[82:85], v[42:45]
    s_add_u32 m0, s21, 12288
    s_add_u32 s93, s21, s23
    s_add_u32 s93, s93, 12288
    buffer_load_dwordx4 v1, s[4:7], s93 offen sc1 lds
    v_mfma_f32_16x16x32_bf16 v[46:49], v[118:121], v[86:89], v[46:49]
    s_waitcnt lgkmcnt(6)
    v_mfma_f32_16x16x32_bf16 v[194:197], v[186:189], a[240:243], v[194:197]
    s_add_u32 m0, s22, 12288
    s_add_u32 s93, s22, s23
    s_add_u32 s93, s93, 12288
    buffer_load_dwordx4 v1, s[4:7], s93 offen sc1 lds
    v_mfma_f32_16x16x32_bf16 v[198:201], a[240:243], v[190:193], v[198:201]
    s_waitcnt vmcnt(17)
    s_waitcnt lgkmcnt(0)
    ds_read_b128 v[186:189], v252 offset:7168
    ds_read_b128 v[190:193], v242 offset:7168
    v_mfma_f32_16x16x32_bf16 v[2:5], v[90:93], v[122:125], v[2:5]
    v_mfma_f32_16x16x32_bf16 v[6:9], v[94:97], v[122:125], v[6:9]
    v_mfma_f32_16x16x32_bf16 v[10:13], v[90:93], v[126:129], v[10:13]
    s_waitcnt vmcnt(20)
    s_barrier
    v_mfma_f32_16x16x32_bf16 v[14:17], v[94:97], v[126:129], v[14:17]
    ds_read_b128 v[66:69], v1 offset:8192
    v_mfma_f32_16x16x32_bf16 v[18:21], v[98:101], v[122:125], v[18:21]
    ds_read_b128 v[70:73], v1 offset:22528
    v_mfma_f32_16x16x32_bf16 v[22:25], v[102:105], v[122:125], v[22:25]
    ds_read_b128 v[74:77], v1 offset:36864
    v_mfma_f32_16x16x32_bf16 v[26:29], v[98:101], v[126:129], v[26:29]
    ds_read_b128 v[78:81], v1 offset:51200
    buffer_load_dwordx4 v[154:157], v1, s[4:7], s80 offen offset:3072 sc1
    v_mfma_f32_16x16x32_bf16 v[30:33], v[102:105], v[126:129], v[30:33]
    ds_read_b128 v[82:85], v243 offset:8192
    v_mfma_f32_16x16x32_bf16 v[34:37], v[122:125], v[106:109], v[34:37]
    ds_read_b128 v[86:89], v243 offset:22528
    v_mfma_f32_16x16x32_bf16 v[38:41], v[122:125], v[110:113], v[38:41]
    buffer_load_dwordx4 v[158:161], v1, s[4:7], s84 offen offset:3072 sc1
    v_mfma_f32_16x16x32_bf16 v[42:45], v[126:129], v[106:109], v[42:45]
    v_mfma_f32_16x16x32_bf16 v[46:49], v[126:129], v[110:113], v[46:49]
    s_waitcnt lgkmcnt(6)
    v_mfma_f32_16x16x32_bf16 v[194:197], v[186:189], a[240:243], v[194:197]
    v_mfma_f32_16x16x32_bf16 v[198:201], a[240:243], v[190:193], v[198:201]
    s_waitcnt vmcnt(7)
    s_waitcnt lgkmcnt(0)
    ds_read_b128 v[186:189], v252 offset:8192
    ds_read_b128 v[190:193], v242 offset:8192
    v_mfma_f32_16x16x32_bf16 v[2:5], v[66:69], v[130:133], v[2:5]
    ds_read_b128 v[90:93], v1 offset:9216
    v_mfma_f32_16x16x32_bf16 v[6:9], v[70:73], v[130:133], v[6:9]
    ds_read_b128 v[94:97], v1 offset:23552
    v_add_f32 v218, v218, v220
    v_add_f32 v222, v222, v224
    v_mfma_f32_16x16x32_bf16 v[10:13], v[66:69], v[134:137], v[10:13]
    ds_read_b128 v[98:101], v1 offset:37888
    v_add_f32 v218, v218, v222
    v_add_f32 v219, v219, v221
    v_mfma_f32_16x16x32_bf16 v[14:17], v[70:73], v[134:137], v[14:17]
    ds_read_b128 v[102:105], v1 offset:52224
    v_add_f32 v223, v223, v225
    v_add_f32 v219, v219, v223
    v_mfma_f32_16x16x32_bf16 v[18:21], v[74:77], v[130:133], v[18:21]
    ds_read_b128 v[106:109], v243 offset:9216
    v_mov_b32 v220, v218
    s_nop 1
    v_permlane32_swap_b32 v218, v220
    v_mfma_f32_16x16x32_bf16 v[22:25], v[78:81], v[130:133], v[22:25]
    ds_read_b128 v[110:113], v243 offset:23552
    v_add_f32 v218, v218, v220
    v_mov_b32 v220, v218
    v_mfma_f32_16x16x32_bf16 v[26:29], v[74:77], v[134:137], v[26:29]
    buffer_load_dwordx4 v[114:117], v1, s[4:7], s81 offen offset:0 sc1
    v_permlane16_swap_b32 v218, v220
    v_add_f32 v218, v218, v220
    v_mfma_f32_16x16x32_bf16 v[30:33], v[78:81], v[134:137], v[30:33]
    v_mov_b32 v221, v219
    s_nop 1
    v_permlane32_swap_b32 v219, v221
    v_mfma_f32_16x16x32_bf16 v[34:37], v[130:133], v[82:85], v[34:37]
    v_add_f32 v219, v219, v221
    v_mov_b32 v221, v219
    v_mfma_f32_16x16x32_bf16 v[38:41], v[130:133], v[86:89], v[38:41]
    buffer_load_dwordx4 v[118:121], v1, s[4:7], s85 offen offset:0 sc1
    v_permlane16_swap_b32 v219, v221
    v_add_f32 v219, v219, v221
    v_mfma_f32_16x16x32_bf16 v[42:45], v[134:137], v[82:85], v[42:45]
    v_mfma_f32_16x16x32_bf16 v[46:49], v[134:137], v[86:89], v[46:49]
    s_waitcnt lgkmcnt(6)
    v_mfma_f32_16x16x32_bf16 v[194:197], v[186:189], a[240:243], v[194:197]
    v_mfma_f32_16x16x32_bf16 v[198:201], a[240:243], v[190:193], v[198:201]
    s_waitcnt vmcnt(10)
    s_waitcnt lgkmcnt(0)
    ds_read_b128 v[186:189], v252 offset:9216
    ds_read_b128 v[190:193], v242 offset:9216
    v_mfma_f32_16x16x32_bf16 v[2:5], v[90:93], v[138:141], v[2:5]
    v_mfma_f32_16x16x32_bf16 v[6:9], v[94:97], v[138:141], v[6:9]
    v_mul_f32 v218, 0x3b124925, v218
    v_mul_f32 v219, 0x3b124925, v219
    v_mfma_f32_16x16x32_bf16 v[10:13], v[90:93], v[142:145], v[10:13]
    s_waitcnt vmcnt(13)
    s_barrier
    v_fma_f32 v219, -v218, v218, v219
    v_max_f32 v219, 0, v219
    v_mfma_f32_16x16x32_bf16 v[14:17], v[94:97], v[142:145], v[14:17]
    ds_read_b128 v[66:69], v1 offset:10240
    buffer_load_dwordx2 v[210:211], v240, s[4:7], s86 offen offset:0 sc1
    v_add_f32 v220, 0x3727c5ac, v219
    v_rsq_f32 v220, v220
    v_mfma_f32_16x16x32_bf16 v[18:21], v[98:101], v[138:141], v[18:21]
    ds_read_b128 v[70:73], v1 offset:24576
    v_mov_b32 v219, v220
    v_mov_b32 v235, v218
    v_mfma_f32_16x16x32_bf16 v[22:25], v[102:105], v[138:141], v[22:25]
    ds_read_b128 v[74:77], v1 offset:38912
    buffer_load_dwordx2 v[212:213], v240, s[4:7], s86 offen offset:512 sc1
    v_mov_b32 v238, v219
    v_add_f32 v226, v226, v228
    v_mfma_f32_16x16x32_bf16 v[26:29], v[98:101], v[142:145], v[26:29]
    ds_read_b128 v[78:81], v1 offset:53248
    buffer_load_dwordx4 v[122:125], v1, s[4:7], s81 offen offset:1024 sc1
    v_add_f32 v230, v230, v232
    v_add_f32 v226, v226, v230
    v_mfma_f32_16x16x32_bf16 v[30:33], v[102:105], v[142:145], v[30:33]
    ds_read_b128 v[82:85], v243 offset:10240
    v_add_f32 v227, v227, v229
    v_add_f32 v231, v231, v233
    v_mfma_f32_16x16x32_bf16 v[34:37], v[138:141], v[106:109], v[34:37]
    ds_read_b128 v[86:89], v243 offset:24576
    v_add_f32 v227, v227, v231
    v_mov_b32 v228, v226
    v_mfma_f32_16x16x32_bf16 v[38:41], v[138:141], v[110:113], v[38:41]
    buffer_load_dwordx4 v[126:129], v1, s[4:7], s85 offen offset:1024 sc1
    v_permlane32_swap_b32 v226, v228
    v_add_f32 v226, v226, v228
    v_mfma_f32_16x16x32_bf16 v[42:45], v[142:145], v[106:109], v[42:45]
    s_mov_b32 m0, s75
    s_nop 0
    buffer_load_dwordx4 v1, s[4:7], s74 offen offset:0 sc1 lds
    buffer_load_dwordx4 v1, s[4:7], s74 offen offset:1024 sc1 lds
    v_mfma_f32_16x16x32_bf16 v[46:49], v[142:145], v[110:113], v[46:49]
    s_waitcnt lgkmcnt(6)
    buffer_load_dwordx4 v1, s[4:7], s74 offen offset:2048 sc1 lds
    buffer_load_dwordx4 v1, s[4:7], s74 offen offset:3072 sc1 lds
    v_mfma_f32_16x16x32_bf16 v[194:197], v[186:189], a[240:243], v[194:197]
    v_mfma_f32_16x16x32_bf16 v[198:201], a[240:243], v[190:193], v[198:201]
    s_waitcnt vmcnt(14)
    s_waitcnt lgkmcnt(0)
    ds_read_b128 v[186:189], v252 offset:10240
    ds_read_b128 v[190:193], v242 offset:10240
    v_mfma_f32_16x16x32_bf16 v[2:5], v[66:69], v[146:149], v[2:5]
    ds_read_b128 v[90:93], v1 offset:11264
    v_mfma_f32_16x16x32_bf16 v[6:9], v[70:73], v[146:149], v[6:9]
    ds_read_b128 v[94:97], v1 offset:25600
    v_mov_b32 v228, v226
    s_nop 1
    v_permlane16_swap_b32 v226, v228
    v_mfma_f32_16x16x32_bf16 v[10:13], v[66:69], v[150:153], v[10:13]
    ds_read_b128 v[98:101], v1 offset:39936
    v_add_f32 v226, v226, v228
    v_mov_b32 v229, v227
    v_mfma_f32_16x16x32_bf16 v[14:17], v[70:73], v[150:153], v[14:17]
    ds_read_b128 v[102:105], v1 offset:54272
    v_permlane32_swap_b32 v227, v229
    v_add_f32 v227, v227, v229
    v_mfma_f32_16x16x32_bf16 v[18:21], v[74:77], v[146:149], v[18:21]
    ds_read_b128 v[106:109], v243 offset:11264
    v_mov_b32 v229, v227
    s_nop 1
    v_permlane16_swap_b32 v227, v229
    v_mfma_f32_16x16x32_bf16 v[22:25], v[78:81], v[146:149], v[22:25]
    ds_read_b128 v[110:113], v243 offset:25600
    v_add_f32 v227, v227, v229
    v_mul_f32 v226, 0x3b124925, v226
    v_mfma_f32_16x16x32_bf16 v[26:29], v[74:77], v[150:153], v[26:29]
    v_mul_f32 v227, 0x3b124925, v227
    v_fma_f32 v227, -v226, v226, v227
    v_mfma_f32_16x16x32_bf16 v[30:33], v[78:81], v[150:153], v[30:33]
    v_max_f32 v227, 0, v227
    v_add_f32 v228, 0x3727c5ac, v227
    v_mfma_f32_16x16x32_bf16 v[34:37], v[146:149], v[82:85], v[34:37]
    buffer_load_dwordx2 v[214:215], v240, s[4:7], s86 offen offset:1024 sc1
    v_rsq_f32 v228, v228
    s_nop 0
    v_mov_b32 v227, v228
    v_mfma_f32_16x16x32_bf16 v[38:41], v[146:149], v[86:89], v[38:41]
    v_mov_b32 v236, v226
    v_mov_b32 v239, v227
    v_mfma_f32_16x16x32_bf16 v[42:45], v[150:153], v[82:85], v[42:45]
    v_mfma_f32_16x16x32_bf16 v[46:49], v[150:153], v[86:89], v[46:49]
    s_waitcnt lgkmcnt(6)
    buffer_load_dwordx2 v[216:217], v241, s[4:7], s86 offen offset:1536 sc1
    v_mfma_f32_16x16x32_bf16 v[194:197], v[186:189], a[240:243], v[194:197]
    v_mfma_f32_16x16x32_bf16 v[198:201], a[240:243], v[190:193], v[198:201]
    s_waitcnt vmcnt(12)
    s_waitcnt lgkmcnt(0)
    ds_read_b128 v[186:189], v252 offset:11264
    ds_read_b128 v[190:193], v242 offset:11264
    v_mfma_f32_16x16x32_bf16 v[2:5], v[90:93], v[154:157], v[2:5]
    v_mfma_f32_16x16x32_bf16 v[6:9], v[94:97], v[154:157], v[6:9]
    v_mfma_f32_16x16x32_bf16 v[10:13], v[90:93], v[158:161], v[10:13]
    s_waitcnt vmcnt(14)
    s_barrier
    v_mfma_f32_16x16x32_bf16 v[14:17], v[94:97], v[158:161], v[14:17]
    ds_read_b128 v[66:69], v1 offset:12288
    v_mfma_f32_16x16x32_bf16 v[18:21], v[98:101], v[154:157], v[18:21]
    ds_read_b128 v[70:73], v1 offset:26624
    v_mfma_f32_16x16x32_bf16 v[22:25], v[102:105], v[154:157], v[22:25]
    ds_read_b128 v[74:77], v1 offset:40960
    v_mfma_f32_16x16x32_bf16 v[26:29], v[98:101], v[158:161], v[26:29]
    ds_read_b128 v[78:81], v1 offset:55296
    v_mfma_f32_16x16x32_bf16 v[30:33], v[102:105], v[158:161], v[30:33]
    ds_read_b128 v[82:85], v243 offset:12288
    v_mfma_f32_16x16x32_bf16 v[34:37], v[154:157], v[106:109], v[34:37]
    ds_read_b128 v[86:89], v243 offset:26624
    v_mfma_f32_16x16x32_bf16 v[38:41], v[154:157], v[110:113], v[38:41]
    v_mfma_f32_16x16x32_bf16 v[42:45], v[158:161], v[106:109], v[42:45]
    v_mfma_f32_16x16x32_bf16 v[46:49], v[158:161], v[110:113], v[46:49]
    s_waitcnt lgkmcnt(6)
    v_mfma_f32_16x16x32_bf16 v[194:197], v[186:189], a[240:243], v[194:197]
    v_mfma_f32_16x16x32_bf16 v[198:201], a[240:243], v[190:193], v[198:201]
    s_waitcnt vmcnt(10)
    s_mov_b32 s30, -1
    s_mov_b32 s31, 0x3fffffff
    s_waitcnt lgkmcnt(0)
    ds_read_b128 v[186:189], v252 offset:12288
    ds_read_b128 v[190:193], v242 offset:12288
    v_mfma_f32_16x16x32_bf16 v[2:5], v[66:69], v[114:117], v[2:5]
    ds_read_b128 v[90:93], v1 offset:13312
    v_mfma_f32_16x16x32_bf16 v[6:9], v[70:73], v[114:117], v[6:9]
    ds_read_b128 v[94:97], v1 offset:27648
    v_mfma_f32_16x16x32_bf16 v[10:13], v[66:69], v[118:121], v[10:13]
    ds_read_b128 v[98:101], v1 offset:41984
    v_mfma_f32_16x16x32_bf16 v[14:17], v[70:73], v[118:121], v[14:17]
    ds_read_b128 v[102:105], v1 offset:56320
    v_mfma_f32_16x16x32_bf16 v[18:21], v[74:77], v[114:117], v[18:21]
    ds_read_b128 v[106:109], v243 offset:13312
    v_mfma_f32_16x16x32_bf16 v[22:25], v[78:81], v[114:117], v[22:25]
    ds_read_b128 v[110:113], v243 offset:27648
    v_mfma_f32_16x16x32_bf16 v[26:29], v[74:77], v[118:121], v[26:29]
    v_mfma_f32_16x16x32_bf16 v[30:33], v[78:81], v[118:121], v[30:33]
    v_mfma_f32_16x16x32_bf16 v[34:37], v[114:117], v[82:85], v[34:37]
    v_mfma_f32_16x16x32_bf16 v[38:41], v[114:117], v[86:89], v[38:41]
    v_mfma_f32_16x16x32_bf16 v[42:45], v[118:121], v[82:85], v[42:45]
    v_mfma_f32_16x16x32_bf16 v[46:49], v[118:121], v[86:89], v[46:49]
    s_waitcnt lgkmcnt(6)
    v_mfma_f32_16x16x32_bf16 v[194:197], v[186:189], a[240:243], v[194:197]
    v_mfma_f32_16x16x32_bf16 v[198:201], a[240:243], v[190:193], v[198:201]
    s_waitcnt vmcnt(0)
    s_waitcnt lgkmcnt(0)
    ds_read_b128 v[186:189], v252 offset:13312
    ds_read_b128 v[190:193], v242 offset:13312
    v_mfma_f32_16x16x32_bf16 v[2:5], v[90:93], v[122:125], v[2:5]
    v_mfma_f32_16x16x32_bf16 v[6:9], v[94:97], v[122:125], v[6:9]
    v_add_f32 v210, v210, v212
    v_add_f32 v214, v214, v216
    v_mfma_f32_16x16x32_bf16 v[10:13], v[90:93], v[126:129], v[10:13]
    v_add_f32 v210, v210, v214
    v_add_f32 v211, v211, v213
    v_mfma_f32_16x16x32_bf16 v[14:17], v[94:97], v[126:129], v[14:17]
    v_add_f32 v215, v215, v217
    v_add_f32 v211, v211, v215
    v_mfma_f32_16x16x32_bf16 v[18:21], v[98:101], v[122:125], v[18:21]
    v_mov_b32 v212, v210
    s_nop 1
    v_permlane32_swap_b32 v210, v212
    v_mfma_f32_16x16x32_bf16 v[22:25], v[102:105], v[122:125], v[22:25]
    v_add_f32 v210, v210, v212
    v_mov_b32 v212, v210
    v_mfma_f32_16x16x32_bf16 v[26:29], v[98:101], v[126:129], v[26:29]
    s_nop 0
    v_permlane16_swap_b32 v210, v212
    v_add_f32 v210, v210, v212
    v_mfma_f32_16x16x32_bf16 v[30:33], v[102:105], v[126:129], v[30:33]
    v_mov_b32 v213, v211
    s_nop 1
    v_permlane32_swap_b32 v211, v213
    v_mfma_f32_16x16x32_bf16 v[34:37], v[122:125], v[106:109], v[34:37]
    s_mov_b64 exec, s[30:31]
    buffer_load_dword v249, v248, s[4:7], 0 offen offset:0 sc1
    s_mov_b64 exec, -1
    v_add_f32 v211, v211, v213
    v_mov_b32 v213, v211
    v_mfma_f32_16x16x32_bf16 v[38:41], v[122:125], v[110:113], v[38:41]
    s_nop 0
    v_permlane16_swap_b32 v211, v213
    v_add_f32 v211, v211, v213
    v_mfma_f32_16x16x32_bf16 v[42:45], v[126:129], v[106:109], v[42:45]
    v_mul_f32 v210, 0x3b124925, v210
    v_mul_f32 v211, 0x3b124925, v211
    v_mfma_f32_16x16x32_bf16 v[46:49], v[126:129], v[110:113], v[46:49]
    s_waitcnt lgkmcnt(0)
    v_fma_f32 v211, -v210, v210, v211
    v_max_f32 v211, 0, v211
    v_mfma_f32_16x16x32_bf16 v[194:197], v[186:189], a[240:243], v[194:197]
    v_mfma_f32_16x16x32_bf16 v[198:201], a[240:243], v[190:193], v[198:201]
    v_cmp_eq_u32 vcc, 0, v250
    s_lshl_b32 s90, s46, 6
    v_add_u32 v252, s90, v244
    s_and_b32 s90, s46, 1
    s_lshl_b32 s90, s90, 6
    v_add_u32 v242, s90, v245
    s_mov_b64 exec, vcc
    ds_write_b128 v252, v[194:197]
    s_mov_b64 exec, 0xffff
    ds_write_b32 v242, v198 offset:256
    s_mov_b64 exec, -1
    s_waitcnt lgkmcnt(0)
    s_barrier
    ds_read_b128 v[66:69], v244 offset:0
    ds_read_b128 v[70:73], v244 offset:64
    ds_read_b128 v[74:77], v244 offset:128
    ds_read_b128 v[78:81], v244 offset:192
    ds_read_b32 v82, v245 offset:256
    ds_read_b32 v83, v245 offset:320
L_a_epi:
    s_add_u32 s90, s46, 2
    s_mul_i32 s90, s90, 14336
    v_add_u32 v246, s90, v1
    v_add_u32 v247, 86016, v1
    s_cmp_lt_u32 s46, 2
    s_cselect_b64 vcc, -1, 0
    v_cndmask_b32 v252, v247, v246, vcc
    v_cndmask_b32 v253, v246, v247, vcc
    v_add_f32 v212, 0x3727c5ac, v211
    v_rsq_f32 v212, v212
    s_nop 0
    v_mov_b32 v211, v212
    v_mov_b32 v234, v210
    v_mov_b32 v237, v211
    s_mov_b64 exec, 0xffff
    ds_write_b32 v162, v234 offset:0
    ds_write_b32 v162, v237 offset:64
    ds_write_b32 v162, v235 offset:128
    ds_write_b32 v162, v238 offset:192
    ds_write_b32 v162, v236 offset:256
    ds_write_b32 v162, v239 offset:320
    s_mov_b64 exec, -1
    ds_read_b128 v[114:117], v163 offset:0
    ds_read_b128 v[126:129], v163 offset:64
    ds_read_b128 v[118:121], v163 offset:128
    ds_read_b128 v[130:133], v163 offset:192
    ds_read_b128 v[122:125], v163 offset:256
    ds_read_b128 v[134:137], v163 offset:320
    s_waitcnt vmcnt(3)
    s_barrier
    ds_read_b128 v[90:93], v252 offset:0
    ds_read_b128 v[94:97], v253 offset:0
    ds_read_b128 v[98:101], v252 offset:1024
    ds_read_b128 v[102:105], v253 offset:1024
    ds_read_b128 v[106:109], v252 offset:2048
    ds_read_b128 v[110:113], v253 offset:2048
    s_waitcnt lgkmcnt(4)
    v_mfma_f32_16x16x32_bf16 v[50:53], v[90:93], v[94:97], 0
    ds_read_b128 v[90:93], v252 offset:3072
    ds_read_b128 v[94:97], v253 offset:3072
    s_waitcnt lgkmcnt(4)
    v_mfma_f32_16x16x32_bf16 v[50:53], v[98:101], v[102:105], v[50:53]
    ds_read_b128 v[98:101], v252 offset:4096
    ds_read_b128 v[102:105], v253 offset:4096
    s_waitcnt lgkmcnt(4)
    v_mfma_f32_16x16x32_bf16 v[50:53], v[106:109], v[110:113], v[50:53]
    ds_read_b128 v[106:109], v252 offset:5120
    ds_read_b128 v[110:113], v253 offset:5120
    s_waitcnt lgkmcnt(4)
    v_mfma_f32_16x16x32_bf16 v[50:53], v[90:93], v[94:97], v[50:53]
    ds_read_b128 v[90:93], v252 offset:6144
    ds_read_b128 v[94:97], v253 offset:6144
    s_waitcnt lgkmcnt(4)
    v_mfma_f32_16x16x32_bf16 v[50:53], v[98:101], v[102:105], v[50:53]
    ds_read_b128 v[98:101], v252 offset:7168
    ds_read_b128 v[102:105], v253 offset:7168
    s_waitcnt lgkmcnt(4)
    v_mfma_f32_16x16x32_bf16 v[50:53], v[106:109], v[110:113], v[50:53]
    ds_read_b128 v[106:109], v252 offset:8192
    ds_read_b128 v[110:113], v253 offset:8192
    s_waitcnt lgkmcnt(4)
    v_mfma_f32_16x16x32_bf16 v[50:53], v[90:93], v[94:97], v[50:53]
    ds_read_b128 v[90:93], v252 offset:9216
    ds_read_b128 v[94:97], v253 offset:9216
    s_waitcnt lgkmcnt(4)
    v_mfma_f32_16x16x32_bf16 v[50:53], v[98:101], v[102:105], v[50:53]
    ds_read_b128 v[98:101], v252 offset:10240
    ds_read_b128 v[102:105], v253 offset:10240
    s_waitcnt lgkmcnt(4)
    v_mfma_f32_16x16x32_bf16 v[50:53], v[106:109], v[110:113], v[50:53]
    ds_read_b128 v[106:109], v252 offset:11264
    ds_read_b128 v[110:113], v253 offset:11264
    s_waitcnt lgkmcnt(4)
    v_mfma_f32_16x16x32_bf16 v[50:53], v[90:93], v[94:97], v[50:53]
    ds_read_b128 v[90:93], v252 offset:12288
    ds_read_b128 v[94:97], v253 offset:12288
    s_waitcnt lgkmcnt(4)
    v_mfma_f32_16x16x32_bf16 v[50:53], v[98:101], v[102:105], v[50:53]
    ds_read_b128 v[98:101], v252 offset:13312
    ds_read_b128 v[102:105], v253 offset:13312
    s_waitcnt lgkmcnt(4)
    v_mfma_f32_16x16x32_bf16 v[50:53], v[106:109], v[110:113], v[50:53]
    s_waitcnt lgkmcnt(2)
    v_mfma_f32_16x16x32_bf16 v[50:53], v[90:93], v[94:97], v[50:53]
    s_waitcnt lgkmcnt(0)
    v_mfma_f32_16x16x32_bf16 v[50:53], v[98:101], v[102:105], v[50:53]
    s_waitcnt vmcnt(0)
    s_mov_b64 exec, s[30:31]
    v_cmp_ne_u32 vcc, s47, v249
    s_mov_b64 exec, -1
    s_nop 2
    s_cbranch_vccz L_early_6
    s_mov_b64 s[94:95], s[30:31]
    s_mov_b64 exec, s[94:95]
    s_mov_b32 s49, 0
L_poll_7:
    buffer_load_dword v253, v248, s[4:7], 0 offen sc1
    s_waitcnt vmcnt(0)
    v_cmp_ne_u32 vcc, s47, v253
    s_nop 4
    s_cbranch_vccz L_polldone_8
    s_add_u32 s49, s49, 1
    s_cmp_lt_u32 s49, 200000
    s_cbranch_scc1 L_poll_7
    s_add_u32 s99, s99, 1
L_polldone_8:
    s_mov_b64 exec, -1
L_early_6:
    s_lshl_b32 s90, s45, 6
    s_lshl_b32 s91, s46, 2
    s_add_u32 s90, s90, s91
    s_lshl_b32 s90, s90, 10
    s_add_u32 s20, s90, 1568768
    s_add_u32 s21, s20, 16384
    s_add_u32 s22, s20, 32768
    s_add_u32 s23, s20, 49152
    buffer_load_dwordx4 v[54:57], v1, s[4:7], s21 offen offset:3072 sc1
    buffer_load_dwordx4 v[58:61], v1, s[4:7], s22 offen offset:3072 sc1
    buffer_load_dwordx4 v[62:65], v1, s[4:7], s23 offen offset:3072 sc1
    s_cmp_eq_u32 s48, 0
    s_cbranch_scc0 L_a_nores
    s_lshr_b32 s91, s46, 1
    s_lshl_b32 s92, s44, 2
    s_add_u32 s91, s91, s92
    s_and_b32 s90, s46, 1
    s_lshl_b32 s92, s45, 1
    s_add_u32 s90, s90, s92
    s_mul_i32 s91, s91, 14
    s_add_u32 s91, s91, s90
    s_lshl_b32 s91, s91, 10
    s_add_u32 s91, s91, 5246976
    buffer_load_dwordx4 a[224:227], v1, s[4:7], s91 offen sc1
    s_add_u32 s91, s91, 28672
    buffer_load_dwordx4 a[228:231], v1, s[4:7], s91 offen sc1
    s_mov_b32 s8, s34
    s_and_b32 s9, s35, 0xffff
    s_mov_b32 s10, 0x380
    s_mov_b32 s11, 0x20000
    s_lshl_b32 s91, s90, 6
    v_lshlrev_b32 v240, 3, v251
    buffer_load_dwordx2 v[228:229], v240, s[8:11], s91 offen
    buffer_load_dwordx2 v[230:231], v240, s[8:11], s91 offen offset:32
L_a_nores:
    v_pk_fma_f32 v[2:3], v[234:235], v[66:67], v[2:3] op_sel:[1,0,0] op_sel_hi:[1,1,1] neg_lo:[1,0,0] neg_hi:[1,0,0]
    v_pk_fma_f32 v[4:5], v[234:235], v[68:69], v[4:5] op_sel:[1,0,0] op_sel_hi:[1,1,1] neg_lo:[1,0,0] neg_hi:[1,0,0]
    v_cvt_pk_bf16_f32 v140, v2, v3
    v_cvt_pk_bf16_f32 v141, v4, v5
    buffer_load_dwordx4 v[2:5], v1, s[4:7], s20 offen offset:0 sc1
    v_pk_fma_f32 v[6:7], v[234:235], v[70:71], v[6:7] op_sel:[1,0,0] op_sel_hi:[1,1,1] neg_lo:[1,0,0] neg_hi:[1,0,0]
    v_pk_fma_f32 v[8:9], v[234:235], v[72:73], v[8:9] op_sel:[1,0,0] op_sel_hi:[1,1,1] neg_lo:[1,0,0] neg_hi:[1,0,0]
    v_cvt_pk_bf16_f32 v142, v6, v7
    v_cvt_pk_bf16_f32 v143, v8, v9
    buffer_load_dwordx4 v[6:9], v1, s[4:7], s21 offen offset:0 sc1
    v_pk_fma_f32 v[10:11], v[236:237], v[66:67], v[10:11] op_sel:[0,0,0] op_sel_hi:[0,1,1] neg_lo:[1,0,0] neg_hi:[1,0,0]
    v_pk_fma_f32 v[12:13], v[236:237], v[68:69], v[12:13] op_sel:[0,0,0] op_sel_hi:[0,1,1] neg_lo:[1,0,0] neg_hi:[1,0,0]
    v_cvt_pk_bf16_f32 v144, v10, v11
    v_cvt_pk_bf16_f32 v145, v12, v13
    buffer_load_dwordx4 v[10:13], v1, s[4:7], s22 offen offset:0 sc1
    v_pk_fma_f32 v[14:15], v[236:237], v[70:71], v[14:15] op_sel:[0,0,0] op_sel_hi:[0,1,1] neg_lo:[1,0,0] neg_hi:[1,0,0]
    v_pk_fma_f32 v[16:17], v[236:237], v[72:73], v[16:17] op_sel:[0,0,0] op_sel_hi:[0,1,1] neg_lo:[1,0,0] neg_hi:[1,0,0]
    v_cvt_pk_bf16_f32 v146, v14, v15
    v_cvt_pk_bf16_f32 v147, v16, v17
    buffer_load_dwordx4 v[14:17], v1, s[4:7], s23 offen offset:0 sc1
    v_pk_fma_f32 v[18:19], v[234:235], v[74:75], v[18:19] op_sel:[1,0,0] op_sel_hi:[1,1,1] neg_lo:[1,0,0] neg_hi:[1,0,0]
    v_pk_fma_f32 v[20:21], v[234:235], v[76:77], v[20:21] op_sel:[1,0,0] op_sel_hi:[1,1,1] neg_lo:[1,0,0] neg_hi:[1,0,0]
    v_cvt_pk_bf16_f32 v152, v18, v19
    v_cvt_pk_bf16_f32 v153, v20, v21
    buffer_load_dwordx4 v[18:21], v1, s[4:7], s20 offen offset:1024 sc1
    v_pk_fma_f32 v[22:23], v[234:235], v[78:79], v[22:23] op_sel:[1,0,0] op_sel_hi:[1,1,1] neg_lo:[1,0,0] neg_hi:[1,0,0]
    v_pk_fma_f32 v[24:25], v[234:235], v[80:81], v[24:25] op_sel:[1,0,0] op_sel_hi:[1,1,1] neg_lo:[1,0,0] neg_hi:[1,0,0]
    v_cvt_pk_bf16_f32 v154, v22, v23
    v_cvt_pk_bf16_f32 v155, v24, v25
    buffer_load_dwordx4 v[22:25], v1, s[4:7], s21 offen offset:1024 sc1
    v_pk_fma_f32 v[26:27], v[236:237], v[74:75], v[26:27] op_sel:[0,0,0] op_sel_hi:[0,1,1] neg_lo:[1,0,0] neg_hi:[1,0,0]
    v_pk_fma_f32 v[28:29], v[236:237], v[76:77], v[28:29] op_sel:[0,0,0] op_sel_hi:[0,1,1] neg_lo:[1,0,0] neg_hi:[1,0,0]
    v_cvt_pk_bf16_f32 v156, v26, v27
    v_cvt_pk_bf16_f32 v157, v28, v29
    buffer_load_dwordx4 v[26:29], v1, s[4:7], s22 offen offset:1024 sc1
    v_pk_fma_f32 v[30:31], v[236:237], v[78:79], v[30:31] op_sel:[0,0,0] op_sel_hi:[0,1,1] neg_lo:[1,0,0] neg_hi:[1,0,0]
    v_pk_fma_f32 v[32:33], v[236:237], v[80:81], v[32:33] op_sel:[0,0,0] op_sel_hi:[0,1,1] neg_lo:[1,0,0] neg_hi:[1,0,0]
    v_cvt_pk_bf16_f32 v158, v30, v31
    v_cvt_pk_bf16_f32 v159, v32, v33
    buffer_load_dwordx4 v[30:33], v1, s[4:7], s23 offen offset:1024 sc1
    s_lshl_b32 s90, s46, 11
    s_add_u32 s90, s90, 102400
    v_add_u32 v246, s90, v1
    s_lshl_b32 s90, s46, 10
    s_add_u32 s90, s90, 112640
    v_add_u32 v247, s90, v1
    s_waitcnt lgkmcnt(0)
    v_pk_fma_f32 v[34:35], v[118:119], v[82:83], v[34:35] op_sel:[0,0,0] op_sel_hi:[1,0,1] neg_lo:[1,0,0] neg_hi:[1,0,0]
    v_pk_fma_f32 v[36:37], v[120:121], v[82:83], v[36:37] op_sel:[0,0,0] op_sel_hi:[1,0,1] neg_lo:[1,0,0] neg_hi:[1,0,0]
    v_cvt_pk_bf16_f32 v162, v34, v35
    v_cvt_pk_bf16_f32 v163, v36, v37
    v_pk_fma_f32 v[38:39], v[118:119], v[82:83], v[38:39] op_sel:[0,1,0] op_sel_hi:[1,1,1] neg_lo:[1,0,0] neg_hi:[1,0,0]
    v_pk_fma_f32 v[40:41], v[120:121], v[82:83], v[40:41] op_sel:[0,1,0] op_sel_hi:[1,1,1] neg_lo:[1,0,0] neg_hi:[1,0,0]
    v_cvt_pk_bf16_f32 v168, v38, v39
    v_cvt_pk_bf16_f32 v169, v40, v41
    v_pk_fma_f32 v[42:43], v[122:123], v[82:83], v[42:43] op_sel:[0,0,0] op_sel_hi:[1,0,1] neg_lo:[1,0,0] neg_hi:[1,0,0]
    v_pk_fma_f32 v[44:45], v[124:125], v[82:83], v[44:45] op_sel:[0,0,0] op_sel_hi:[1,0,1] neg_lo:[1,0,0] neg_hi:[1,0,0]
    v_cvt_pk_bf16_f32 v164, v42, v43
    v_cvt_pk_bf16_f32 v165, v44, v45
    v_pk_fma_f32 v[46:47], v[122:123], v[82:83], v[46:47] op_sel:[0,1,0] op_sel_hi:[1,1,1] neg_lo:[1,0,0] neg_hi:[1,0,0]
    v_pk_fma_f32 v[48:49], v[124:125], v[82:83], v[48:49] op_sel:[0,1,0] op_sel_hi:[1,1,1] neg_lo:[1,0,0] neg_hi:[1,0,0]
    v_cvt_pk_bf16_f32 v170, v46, v47
    v_cvt_pk_bf16_f32 v171, v48, v49
    ds_write_b128 v246, v[156:159] offset:2048
    ds_write_b64 v246, v[164:165] offset:3072
    ds_write_b64 v246, v[170:171] offset:3080
    ds_write_b128 v247, v[50:53]
    s_mul_i32 s90, s48, 2097152
    s_add_u32 s90, s90, 9375744
    s_lshl_b32 s91, s98, 4
    s_add_u32 s91, s91, s43
    s_lshl_b32 s91, s91, 10
    s_add_u32 s32, s90, s91
    s_add_u32 s33, s32, 16384
    s_waitcnt lgkmcnt(0)
    s_barrier
    s_cmp_eq_u32 s46, 0
    s_cbranch_scc1 L_a_halo
    ds_read_b128 v[148:151], v246
    ds_read_b64 v[160:161], v246 offset:1024
    ds_read_b64 v[166:167], v246 offset:1032
    s_waitcnt lgkmcnt(0)
    s_branch L_a_prev
L_a_halo:
    v_add_u32 v247, 112640, v1
    ds_read_b128 v[172:175], v247 offset:0
    ds_read_b128 v[176:179], v247 offset:1024
    ds_read_b128 v[180:183], v247 offset:2048
    ds_read_b128 v[184:187], v247 offset:3072
    s_waitcnt lgkmcnt(0)
    v_pk_fma_f32 v[172:173], v[234:235], v[74:75], v[172:173] op_sel:[0,0,0] op_sel_hi:[0,1,1] neg_lo:[1,0,0] neg_hi:[1,0,0]
    v_pk_fma_f32 v[174:175], v[234:235], v[76:77], v[174:175] op_sel:[0,0,0] op_sel_hi:[0,1,1] neg_lo:[1,0,0] neg_hi:[1,0,0]
    v_cvt_pk_bf16_f32 v148, v172, v173
    v_cvt_pk_bf16_f32 v149, v174, v175
    v_pk_fma_f32 v[176:177], v[234:235], v[78:79], v[176:177] op_sel:[0,0,0] op_sel_hi:[0,1,1] neg_lo:[1,0,0] neg_hi:[1,0,0]
    v_pk_fma_f32 v[178:179], v[234:235], v[80:81], v[178:179] op_sel:[0,0,0] op_sel_hi:[0,1,1] neg_lo:[1,0,0] neg_hi:[1,0,0]
    v_cvt_pk_bf16_f32 v150, v176, v177
    v_cvt_pk_bf16_f32 v151, v178, v179
    v_pk_fma_f32 v[180:181], v[114:115], v[82:83], v[180:181] op_sel:[0,0,0] op_sel_hi:[1,0,1] neg_lo:[1,0,0] neg_hi:[1,0,0]
    v_pk_fma_f32 v[182:183], v[116:117], v[82:83], v[182:183] op_sel:[0,0,0] op_sel_hi:[1,0,1] neg_lo:[1,0,0] neg_hi:[1,0,0]
    v_cvt_pk_bf16_f32 v160, v180, v181
    v_cvt_pk_bf16_f32 v161, v182, v183
    v_pk_fma_f32 v[184:185], v[114:115], v[82:83], v[184:185] op_sel:[0,1,0] op_sel_hi:[1,1,1] neg_lo:[1,0,0] neg_hi:[1,0,0]
    v_pk_fma_f32 v[186:187], v[116:117], v[82:83], v[186:187] op_sel:[0,1,0] op_sel_hi:[1,1,1] neg_lo:[1,0,0] neg_hi:[1,0,0]
    v_cvt_pk_bf16_f32 v166, v184, v185
    v_cvt_pk_bf16_f32 v167, v186, v187
L_a_prev:
    s_nop 1
    v_mfma_f32_16x16x32_bf16 v[172:175], v[148:151], v[140:143], 0
    v_mfma_f32_16x16x32_bf16 v[176:179], v[152:155], v[140:143], 0
    v_mfma_f32_16x16x32_bf16 v[180:183], v[152:155], v[144:147], 0
    v_mfma_f32_16x16x32_bf16 v[184:187], v[156:159], v[144:147], 0
    v_mov_b32 v198, 0xff800000
    s_nop 3
    v_pk_mul_f32 v[172:173], v[172:173], v[126:127] op_sel:[0,0] op_sel_hi:[1,1]
    s_nop 0
    v_pk_mul_f32 v[180:181], v[180:181], v[130:131] op_sel:[0,0] op_sel_hi:[1,1]
    v_pk_mul_f32 v[174:175], v[174:175], v[128:129] op_sel:[0,0] op_sel_hi:[1,1]
    v_pk_mul_f32 v[182:183], v[182:183], v[132:133] op_sel:[0,0] op_sel_hi:[1,1]
    v_pk_mul_f32 v[176:177], v[176:177], v[130:131] op_sel:[0,0] op_sel_hi:[1,1]
    v_pk_mul_f32 v[184:185], v[184:185], v[134:135] op_sel:[0,0] op_sel_hi:[1,1]
    v_pk_mul_f32 v[178:179], v[178:179], v[132:133] op_sel:[0,0] op_sel_hi:[1,1]
    v_pk_mul_f32 v[186:187], v[186:187], v[136:137] op_sel:[0,0] op_sel_hi:[1,1]
    v_cndmask_b32 v172, v198, v172, s[66:67]
    v_cndmask_b32 v180, v198, v180, s[50:51]
    v_cndmask_b32 v173, v198, v173, s[68:69]
    v_cndmask_b32 v181, v198, v181, s[52:53]
    v_cndmask_b32 v174, v198, v174, s[70:71]
    v_cndmask_b32 v182, v198, v182, s[54:55]
    v_cndmask_b32 v175, v198, v175, s[72:73]
    v_cndmask_b32 v183, v198, v183, s[56:57]
    v_cndmask_b32 v176, v198, v176, s[58:59]
    v_cndmask_b32 v184, v198, v184, s[58:59]
    buffer_load_dwordx4 v[34:37], v1, s[4:7], s20 offen offset:2048 sc1
    v_cndmask_b32 v177, v198, v177, s[60:61]
    v_cndmask_b32 v185, v198, v185, s[60:61]
    v_cndmask_b32 v178, v198, v178, s[62:63]
    v_cndmask_b32 v186, v198, v186, s[62:63]
    v_cndmask_b32 v179, v198, v179, s[64:65]
    v_cndmask_b32 v187, v198, v187, s[64:65]
    v_max3_f32 v190, v172, v173, v174
    v_max3_f32 v191, v180, v181, v182
    v_max3_f32 v190, v190, v175, v176
    v_max3_f32 v191, v191, v183, v184
    v_max3_f32 v190, v190, v177, v178
    v_max3_f32 v191, v191, v185, v186
    v_max_f32 v190, v190, v179
    v_max_f32 v191, v191, v187
    v_mov_b32 v196, v190
    v_mov_b32 v197, v191
    s_nop 0
    v_permlane32_swap_b32 v190, v196
    v_permlane32_swap_b32 v191, v197
    buffer_load_dwordx4 v[38:41], v1, s[4:7], s21 offen offset:2048 sc1
    v_max_f32 v190, v190, v196
    v_max_f32 v191, v191, v197
    v_mov_b32 v196, v190
    v_mov_b32 v197, v191
    s_nop 0
    v_permlane16_swap_b32 v190, v196
    v_permlane16_swap_b32 v191, v197
    v_max_f32 v190, v190, v196
    v_max_f32 v191, v191, v197
    v_mul_f32 v192, 0x3e8b97f6, v238
    v_mul_f32 v193, 0x3e8b97f6, v239
    v_mul_f32 v190, v190, v192
    v_mul_f32 v191, v191, v193
    v_pk_fma_f32 v[172:173], v[172:173], v[192:193], v[190:191] op_sel:[0,0,0] op_sel_hi:[1,0,0] neg_lo:[0,0,1] neg_hi:[0,0,1]
    v_pk_fma_f32 v[180:181], v[180:181], v[192:193], v[190:191] op_sel:[0,1,1] op_sel_hi:[1,1,1] neg_lo:[0,0,1] neg_hi:[0,0,1]
    v_pk_fma_f32 v[174:175], v[174:175], v[192:193], v[190:191] op_sel:[0,0,0] op_sel_hi:[1,0,0] neg_lo:[0,0,1] neg_hi:[0,0,1]
    v_pk_fma_f32 v[182:183], v[182:183], v[192:193], v[190:191] op_sel:[0,1,1] op_sel_hi:[1,1,1] neg_lo:[0,0,1] neg_hi:[0,0,1]
    v_pk_fma_f32 v[176:177], v[176:177], v[192:193], v[190:191] op_sel:[0,0,0] op_sel_hi:[1,0,0] neg_lo:[0,0,1] neg_hi:[0,0,1]
    v_pk_fma_f32 v[184:185], v[184:185], v[192:193], v[190:191] op_sel:[0,1,1] op_sel_hi:[1,1,1] neg_lo:[0,0,1] neg_hi:[0,0,1]
    buffer_load_dwordx4 v[42:45], v1, s[4:7], s22 offen offset:2048 sc1
    v_pk_fma_f32 v[178:179], v[178:179], v[192:193], v[190:191] op_sel:[0,0,0] op_sel_hi:[1,0,0] neg_lo:[0,0,1] neg_hi:[0,0,1]
    v_pk_fma_f32 v[186:187], v[186:187], v[192:193], v[190:191] op_sel:[0,1,1] op_sel_hi:[1,1,1] neg_lo:[0,0,1] neg_hi:[0,0,1]
    v_exp_f32 v172, v172
    v_exp_f32 v180, v180
    v_exp_f32 v173, v173
    v_exp_f32 v181, v181
    v_exp_f32 v174, v174
    v_exp_f32 v182, v182
    v_exp_f32 v175, v175
    v_exp_f32 v183, v183
    v_exp_f32 v176, v176
    v_exp_f32 v184, v184
    v_exp_f32 v177, v177
    v_exp_f32 v185, v185
    v_exp_f32 v178, v178
    v_exp_f32 v186, v186
    v_exp_f32 v179, v179
    v_exp_f32 v187, v187
    buffer_load_dwordx4 v[46:49], v1, s[4:7], s23 offen offset:2048 sc1
    v_pk_add_f32 v[224:225], v[172:173], v[174:175] op_sel:[0,0] op_sel_hi:[1,1]
    v_pk_add_f32 v[232:233], v[180:181], v[182:183] op_sel:[0,0] op_sel_hi:[1,1]
    v_pk_add_f32 v[226:227], v[176:177], v[178:179] op_sel:[0,0] op_sel_hi:[1,1]
    v_pk_add_f32 v[188:189], v[184:185], v[186:187] op_sel:[0,0] op_sel_hi:[1,1]
    v_pk_add_f32 v[224:225], v[224:225], v[226:227] op_sel:[0,0] op_sel_hi:[1,1]
    v_pk_add_f32 v[232:233], v[232:233], v[188:189] op_sel:[0,0] op_sel_hi:[1,1]
    v_add_f32 v194, v224, v225
    v_add_f32 v195, v232, v233
    v_mov_b32 v196, v194
    v_mov_b32 v197, v195
    s_nop 0
    v_permlane32_swap_b32 v194, v196
    v_permlane32_swap_b32 v195, v197
    v_add_f32 v194, v194, v196
    v_add_f32 v195, v195, v197
    v_mov_b32 v196, v194
    v_mov_b32 v197, v195
    s_nop 0
    v_permlane16_swap_b32 v194, v196
    v_permlane16_swap_b32 v195, v197
    buffer_load_dwordx4 v[50:53], v1, s[4:7], s20 offen offset:3072 sc1
    v_add_f32 v194, v194, v196
    v_add_f32 v195, v195, v197
    v_rcp_f32 v194, v194
    v_rcp_f32 v195, v195
    v_pk_mul_f32 v[172:173], v[172:173], v[126:127] op_sel:[0,0] op_sel_hi:[1,1]
    v_pk_mul_f32 v[180:181], v[180:181], v[130:131] op_sel:[0,0] op_sel_hi:[1,1]
    v_pk_mul_f32 v[174:175], v[174:175], v[128:129] op_sel:[0,0] op_sel_hi:[1,1]
    v_pk_mul_f32 v[182:183], v[182:183], v[132:133] op_sel:[0,0] op_sel_hi:[1,1]
    v_pk_mul_f32 v[176:177], v[176:177], v[130:131] op_sel:[0,0] op_sel_hi:[1,1]
    v_pk_mul_f32 v[184:185], v[184:185], v[134:135] op_sel:[0,0] op_sel_hi:[1,1]
    v_pk_mul_f32 v[178:179], v[178:179], v[132:133] op_sel:[0,0] op_sel_hi:[1,1]
    v_pk_mul_f32 v[186:187], v[186:187], v[136:137] op_sel:[0,0] op_sel_hi:[1,1]
    v_cvt_pk_bf16_f32 v200, v172, v173
    v_cvt_pk_bf16_f32 v204, v180, v181
    v_cvt_pk_bf16_f32 v201, v174, v175
    v_cvt_pk_bf16_f32 v205, v182, v183
    v_cvt_pk_bf16_f32 v202, v176, v177
    v_cvt_pk_bf16_f32 v206, v184, v185
    v_cvt_pk_bf16_f32 v203, v178, v179
    v_cvt_pk_bf16_f32 v207, v186, v187
    s_nop 0
    v_mfma_f32_16x16x32_bf16 v[208:211], v[160:163], v[200:203], 0
    v_mfma_f32_16x16x32_bf16 v[212:215], v[166:169], v[200:203], 0
    v_mfma_f32_16x16x32_bf16 v[216:219], v[162:165], v[204:207], 0
    v_mfma_f32_16x16x32_bf16 v[220:223], v[168:171], v[204:207], 0
    s_nop 4
    v_pk_mul_f32 v[208:209], v[208:209], v[194:195] op_sel:[0,0] op_sel_hi:[1,0]
    v_pk_mul_f32 v[210:211], v[210:211], v[194:195] op_sel:[0,0] op_sel_hi:[1,0]
    v_pk_mul_f32 v[212:213], v[212:213], v[194:195] op_sel:[0,0] op_sel_hi:[1,0]
    v_pk_mul_f32 v[214:215], v[214:215], v[194:195] op_sel:[0,0] op_sel_hi:[1,0]
    v_cvt_pk_bf16_f32 v200, v208, v209
    v_cvt_pk_bf16_f32 v201, v210, v211
    v_cvt_pk_bf16_f32 v202, v212, v213
    v_cvt_pk_bf16_f32 v203, v214, v215
    buffer_store_dwordx4 v[200:203], v1, s[4:7], s32 offen sc1
    v_pk_mul_f32 v[216:217], v[216:217], v[194:195] op_sel:[0,1] op_sel_hi:[1,1]
    v_pk_mul_f32 v[218:219], v[218:219], v[194:195] op_sel:[0,1] op_sel_hi:[1,1]
    v_pk_mul_f32 v[220:221], v[220:221], v[194:195] op_sel:[0,1] op_sel_hi:[1,1]
    v_pk_mul_f32 v[222:223], v[222:223], v[194:195] op_sel:[0,1] op_sel_hi:[1,1]
    v_cvt_pk_bf16_f32 v204, v216, v217
    v_cvt_pk_bf16_f32 v205, v218, v219
    v_cvt_pk_bf16_f32 v206, v220, v221
    v_cvt_pk_bf16_f32 v207, v222, v223
    buffer_store_dwordx4 v[204:207], v1, s[4:7], s33 offen sc1
    s_mul_i32 s90, s48, 8192
    s_add_u32 s90, s90, 45056
    s_lshl_b32 s91, s98, 4
    s_add_u32 s91, s91, s43
    s_lshl_b32 s91, s91, 2
    s_add_u32 s90, s90, s91
    v_lshlrev_b32 v241, 6, v0
    v_add_u32 v241, s90, v241
    s_mul_i32 s90, s48, 8192
    s_add_u32 s90, s90, 45056
    s_lshl_b32 s91, s44, 8
    s_add_u32 s90, s90, s91
    v_lshl_add_u32 v240, v0, 2, s90
    s_lshl_b32 s91, s46, 2
    s_lshl_b32 s94, 0x000f000f, s91
    s_mov_b32 s95, s94
    s_lshl_b32 s90, s46, 13
    s_add_u32 s90, s90, 86016
    v_add_u32 v248, s90, v1
    s_and_b32 s90, s46, 1
    s_lshl_b32 s90, s90, 11
    s_lshr_b32 s91, s46, 1
    s_lshl_b32 s91, s91, 12
    s_add_u32 s90, s90, s91
    s_add_u32 s90, s90, 86016
    v_add_u32 v249, s90, v1
    s_lshr_b32 s91, s46, 1
    s_lshl_b32 s92, s44, 2
    s_add_u32 s91, s91, s92
    s_and_b32 s90, s46, 1
    s_lshl_b32 s92, s45, 1
    s_add_u32 s90, s90, s92
    s_mul_i32 s92, s91, 14
    s_add_u32 s92, s92, s90
    s_lshl_b32 s36, s92, 10
    s_lshl_b32 s37, s92, 7
    s_lshl_b32 s28, s91, 4
    s_add_u32 s28, s28, s90
    s_lshl_b32 s28, s28, 2
    s_mul_i32 s93, s48, 1835008
    s_add_u32 s93, s93, 13570048
    s_add_u32 s36, s36, s93
    s_mul_i32 s93, s48, 229376
    s_add_u32 s93, s93, 17240064
    s_add_u32 s37, s37, s93
    s_mul_i32 s93, s48, 8192
    s_add_u32 s93, s93, 61440
    s_add_u32 s28, s28, s93
    s_add_u32 s33, s36, 28672
    s_mov_b32 s29, s27
    s_mov_b32 s26, s101
    s_mul_i32 s90, s48, 2097152
    s_add_u32 s90, s90, 9375744
    s_lshl_b32 s91, s44, 6
    s_lshl_b32 s92, s46, 2
    s_add_u32 s91, s91, s92
    s_lshl_b32 s91, s91, 10
    s_add_u32 s20, s90, s91
    s_add_u32 s21, s20, 16384
    s_add_u32 s22, s20, 32768
    s_add_u32 s23, s20, 49152
    s_waitcnt vmcnt(0)
    s_mov_b64 exec, 3
    s_cmp_eq_u32 s101, 0
    s_cbranch_scc1 L_slow_9
    buffer_store_dword v254, v241, s[4:7], 0 offen
    s_branch L_st_10
L_slow_9:
    buffer_store_dword v254, v241, s[4:7], 0 offen sc1
L_st_10:
    s_mov_b64 exec, -1
    s_cmp_eq_u32 s45, 7
    s_cbranch_scc1 L_next_pair
    s_cmp_eq_u32 s48, 0
    s_cbranch_scc0 L_b_start
    v_lshlrev_b32 v236, 16, v228
    v_and_b32 v237, 0xffff0000, v228
    v_accvgpr_write_b32 a232, v236
    v_accvgpr_write_b32 a233, v237
    v_lshlrev_b32 v236, 16, v229
    v_and_b32 v237, 0xffff0000, v229
    v_accvgpr_write_b32 a234, v236
    v_accvgpr_write_b32 a235, v237
    v_lshlrev_b32 v236, 16, v230
    v_and_b32 v237, 0xffff0000, v230
    v_accvgpr_write_b32 a236, v236
    v_accvgpr_write_b32 a237, v237
    v_lshlrev_b32 v236, 16, v231
    v_and_b32 v237, 0xffff0000, v231
    v_accvgpr_write_b32 a238, v236
    v_accvgpr_write_b32 a239, v237
L_b_start:
    s_lshr_b32 s90, s43, 3
    s_mul_i32 s90, s90, 7
    s_add_u32 s41, s90, s45
    s_lshl_b32 s90, s41, 3
    s_lshl_b32 s91, s46, 1
    s_add_u32 s90, s90, s91
    s_mul_i32 s91, s90, 14336
    s_add_u32 s74, s91, 2027520
    s_add_u32 s75, s74, 4096
    s_add_u32 s76, s74, 8192
    s_add_u32 s77, s74, 12288
    s_add_u32 s78, s74, 14336
    s_add_u32 s79, s78, 4096
    s_add_u32 s80, s78, 8192
    s_add_u32 s81, s78, 12288
    s_mov_b64 exec, s[94:95]
    s_mov_b32 s49, 0
L_poll_11:
    buffer_load_dword v253, v240, s[4:7], 0 offen sc1
    s_waitcnt vmcnt(0)
    v_cmp_ne_u32 vcc, s47, v253
    s_nop 4
    s_cbranch_vccz L_polldone_12
    s_add_u32 s49, s49, 1
    s_cmp_lt_u32 s49, 200000
    s_cbranch_scc1 L_poll_11
    s_add_u32 s99, s99, 1
L_polldone_12:
    s_mov_b64 exec, -1
    s_barrier
    s_or_b32 s90, s2, s46
    s_or_b32 s90, s90, s48
    s_cmp_eq_u32 s90, 0
    s_cbranch_scc0 L_noepoch
    s_add_u32 s90, s1, 1
    v_mov_b32 v239, s90
    s_mov_b64 exec, 1
    buffer_store_dword v239, off, s[4:7], 0 sc1
    s_mov_b64 exec, -1
L_noepoch:
    buffer_load_dwordx4 v[66:69], v1, s[4:7], s20 offen offset:0 sc1
    buffer_load_dwordx4 v[70:73], v1, s[4:7], s20 offen offset:1024 sc1
    buffer_load_dwordx4 v[74:77], v1, s[4:7], s20 offen offset:2048 sc1
    buffer_load_dwordx4 v[78:81], v1, s[4:7], s20 offen offset:3072 sc1
    buffer_load_dwordx4 v[82:85], v1, s[4:7], s21 offen offset:0 sc1
    buffer_load_dwordx4 v[86:89], v1, s[4:7], s21 offen offset:1024 sc1
    buffer_load_dwordx4 v[90:93], v1, s[4:7], s21 offen offset:2048 sc1
    buffer_load_dwordx4 v[94:97], v1, s[4:7], s21 offen offset:3072 sc1
    s_waitcnt vmcnt(7)
    v_mfma_f32_16x16x32_bf16 v[130:133], v[2:5], v[66:69], 0
    v_mfma_f32_16x16x32_bf16 v[134:137], v[6:9], v[66:69], 0
    buffer_load_dwordx4 v[98:101], v1, s[4:7], s22 offen offset:0 sc1
    v_mfma_f32_16x16x32_bf16 v[138:141], v[10:13], v[66:69], 0
    v_mfma_f32_16x16x32_bf16 v[142:145], v[14:17], v[66:69], 0
    s_waitcnt vmcnt(7)
    v_mfma_f32_16x16x32_bf16 v[130:133], v[18:21], v[70:73], v[130:133]
    v_mfma_f32_16x16x32_bf16 v[134:137], v[22:25], v[70:73], v[134:137]
    buffer_load_dwordx4 v[102:105], v1, s[4:7], s22 offen offset:1024 sc1
    v_mfma_f32_16x16x32_bf16 v[138:141], v[26:29], v[70:73], v[138:141]
    v_mfma_f32_16x16x32_bf16 v[142:145], v[30:33], v[70:73], v[142:145]
    s_waitcnt vmcnt(7)
    v_mfma_f32_16x16x32_bf16 v[130:133], v[34:37], v[74:77], v[130:133]
    v_mfma_f32_16x16x32_bf16 v[134:137], v[38:41], v[74:77], v[134:137]
    buffer_load_dwordx4 v[106:109], v1, s[4:7], s22 offen offset:2048 sc1
    v_mfma_f32_16x16x32_bf16 v[138:141], v[42:45], v[74:77], v[138:141]
    v_mfma_f32_16x16x32_bf16 v[142:145], v[46:49], v[74:77], v[142:145]
    s_waitcnt vmcnt(7)
    v_mfma_f32_16x16x32_bf16 v[130:133], v[50:53], v[78:81], v[130:133]
    v_mfma_f32_16x16x32_bf16 v[134:137], v[54:57], v[78:81], v[134:137]
    buffer_load_dwordx4 v[110:113], v1, s[4:7], s22 offen offset:3072 sc1
    v_mfma_f32_16x16x32_bf16 v[138:141], v[58:61], v[78:81], v[138:141]
    v_mfma_f32_16x16x32_bf16 v[142:145], v[62:65], v[78:81], v[142:145]
    s_waitcnt vmcnt(7)
    v_mfma_f32_16x16x32_bf16 v[146:149], v[2:5], v[82:85], 0
    v_mfma_f32_16x16x32_bf16 v[150:153], v[6:9], v[82:85], 0
    buffer_load_dwordx4 v[114:117], v1, s[4:7], s23 offen offset:0 sc1
    v_mfma_f32_16x16x32_bf16 v[154:157], v[10:13], v[82:85], 0
    v_mfma_f32_16x16x32_bf16 v[158:161], v[14:17], v[82:85], 0
    ds_write_b128 v248, v[130:133] offset:0
    s_waitcnt vmcnt(7)
    v_mfma_f32_16x16x32_bf16 v[146:149], v[18:21], v[86:89], v[146:149]
    ds_write_b128 v248, v[134:137] offset:1024
    v_mfma_f32_16x16x32_bf16 v[150:153], v[22:25], v[86:89], v[150:153]
    buffer_load_dwordx4 v[118:121], v1, s[4:7], s23 offen offset:1024 sc1
    v_mfma_f32_16x16x32_bf16 v[154:157], v[26:29], v[86:89], v[154:157]
    ds_write_b128 v248, v[138:141] offset:2048
    v_mfma_f32_16x16x32_bf16 v[158:161], v[30:33], v[86:89], v[158:161]
    ds_write_b128 v248, v[142:145] offset:3072
    s_waitcnt vmcnt(7)
    v_mfma_f32_16x16x32_bf16 v[146:149], v[34:37], v[90:93], v[146:149]
    v_mfma_f32_16x16x32_bf16 v[150:153], v[38:41], v[90:93], v[150:153]
    buffer_load_dwordx4 v[122:125], v1, s[4:7], s23 offen offset:2048 sc1
    v_mfma_f32_16x16x32_bf16 v[154:157], v[42:45], v[90:93], v[154:157]
    v_mfma_f32_16x16x32_bf16 v[158:161], v[46:49], v[90:93], v[158:161]
    s_waitcnt vmcnt(7)
    v_mfma_f32_16x16x32_bf16 v[146:149], v[50:53], v[94:97], v[146:149]
    v_mfma_f32_16x16x32_bf16 v[150:153], v[54:57], v[94:97], v[150:153]
    buffer_load_dwordx4 v[126:129], v1, s[4:7], s23 offen offset:3072 sc1
    v_mfma_f32_16x16x32_bf16 v[154:157], v[58:61], v[94:97], v[154:157]
    v_mfma_f32_16x16x32_bf16 v[158:161], v[62:65], v[94:97], v[158:161]
    s_waitcnt vmcnt(7)
    v_mfma_f32_16x16x32_bf16 v[162:165], v[2:5], v[98:101], 0
    v_mfma_f32_16x16x32_bf16 v[166:169], v[6:9], v[98:101], 0
    buffer_load_dwordx4 v[66:69], v1, s[4:7], s74 offen offset:0 sc1
    v_mfma_f32_16x16x32_bf16 v[170:173], v[10:13], v[98:101], 0
    v_mfma_f32_16x16x32_bf16 v[174:177], v[14:17], v[98:101], 0
    ds_write_b128 v248, v[146:149] offset:4096
    s_waitcnt vmcnt(7)
    v_mfma_f32_16x16x32_bf16 v[162:165], v[18:21], v[102:105], v[162:165]
    ds_write_b128 v248, v[150:153] offset:5120
    v_mfma_f32_16x16x32_bf16 v[166:169], v[22:25], v[102:105], v[166:169]
    buffer_load_dwordx4 v[70:73], v1, s[4:7], s78 offen offset:0 sc1
    v_mfma_f32_16x16x32_bf16 v[170:173], v[26:29], v[102:105], v[170:173]
    ds_write_b128 v248, v[154:157] offset:6144
    v_mfma_f32_16x16x32_bf16 v[174:177], v[30:33], v[102:105], v[174:177]
    ds_write_b128 v248, v[158:161] offset:7168
    s_waitcnt vmcnt(7)
    v_mfma_f32_16x16x32_bf16 v[162:165], v[34:37], v[106:109], v[162:165]
    v_mfma_f32_16x16x32_bf16 v[166:169], v[38:41], v[106:109], v[166:169]
    buffer_load_dwordx4 v[74:77], v1, s[4:7], s74 offen offset:1024 sc1
    v_mfma_f32_16x16x32_bf16 v[170:173], v[42:45], v[106:109], v[170:173]
    v_mfma_f32_16x16x32_bf16 v[174:177], v[46:49], v[106:109], v[174:177]
    s_waitcnt vmcnt(7)
    v_mfma_f32_16x16x32_bf16 v[162:165], v[50:53], v[110:113], v[162:165]
    v_mfma_f32_16x16x32_bf16 v[166:169], v[54:57], v[110:113], v[166:169]
    buffer_load_dwordx4 v[78:81], v1, s[4:7], s78 offen offset:1024 sc1
    v_mfma_f32_16x16x32_bf16 v[170:173], v[58:61], v[110:113], v[170:173]
    v_mfma_f32_16x16x32_bf16 v[174:177], v[62:65], v[110:113], v[174:177]
    s_waitcnt vmcnt(7)
    v_mfma_f32_16x16x32_bf16 v[178:181], v[2:5], v[114:117], 0
    v_mfma_f32_16x16x32_bf16 v[182:185], v[6:9], v[114:117], 0
    buffer_load_dwordx4 v[82:85], v1, s[4:7], s74 offen offset:2048 sc1
    v_mfma_f32_16x16x32_bf16 v[186:189], v[10:13], v[114:117], 0
    v_mfma_f32_16x16x32_bf16 v[190:193], v[14:17], v[114:117], 0
    ds_write_b128 v248, v[162:165] offset:32768
    s_waitcnt vmcnt(7)
    v_mfma_f32_16x16x32_bf16 v[178:181], v[18:21], v[118:121], v[178:181]
    ds_write_b128 v248, v[166:169] offset:33792
    v_mfma_f32_16x16x32_bf16 v[182:185], v[22:25], v[118:121], v[182:185]
    buffer_load_dwordx4 v[86:89], v1, s[4:7], s78 offen offset:2048 sc1
    v_mfma_f32_16x16x32_bf16 v[186:189], v[26:29], v[118:121], v[186:189]
    ds_write_b128 v248, v[170:173] offset:34816
    v_mfma_f32_16x16x32_bf16 v[190:193], v[30:33], v[118:121], v[190:193]
    ds_write_b128 v248, v[174:177] offset:35840
    s_waitcnt vmcnt(7)
    v_mfma_f32_16x16x32_bf16 v[178:181], v[34:37], v[122:125], v[178:181]
    v_mfma_f32_16x16x32_bf16 v[182:185], v[38:41], v[122:125], v[182:185]
    buffer_load_dwordx4 v[90:93], v1, s[4:7], s74 offen offset:3072 sc1
    v_mfma_f32_16x16x32_bf16 v[186:189], v[42:45], v[122:125], v[186:189]
    v_mfma_f32_16x16x32_bf16 v[190:193], v[46:49], v[122:125], v[190:193]
    s_waitcnt vmcnt(7)
    v_mfma_f32_16x16x32_bf16 v[178:181], v[50:53], v[126:129], v[178:181]
    v_mfma_f32_16x16x32_bf16 v[182:185], v[54:57], v[126:129], v[182:185]
    buffer_load_dwordx4 v[94:97], v1, s[4:7], s78 offen offset:3072 sc1
    v_mfma_f32_16x16x32_bf16 v[186:189], v[58:61], v[126:129], v[186:189]
    v_mfma_f32_16x16x32_bf16 v[190:193], v[62:65], v[126:129], v[190:193]
    s_nop 3
    ds_write_b128 v248, v[178:181] offset:36864
    ds_write_b128 v248, v[182:185] offset:37888
    s_nop 0
    ds_write_b128 v248, v[186:189] offset:38912
    ds_write_b128 v248, v[190:193] offset:39936
    v_accvgpr_read_b32 v234, a224
    v_accvgpr_read_b32 v235, a225
    v_accvgpr_read_b32 v236, a226
    v_accvgpr_read_b32 v237, a227
    v_lshlrev_b32 v226, 16, v234
    v_and_b32 v227, 0xffff0000, v234
    v_lshlrev_b32 v228, 16, v235
    v_and_b32 v229, 0xffff0000, v235
    v_lshlrev_b32 v230, 16, v236
    v_and_b32 v231, 0xffff0000, v236
    v_lshlrev_b32 v232, 16, v237
    v_and_b32 v233, 0xffff0000, v237
    v_accvgpr_read_b32 v10, a228
    v_accvgpr_read_b32 v11, a229
    v_accvgpr_read_b32 v12, a230
    v_accvgpr_read_b32 v13, a231
    v_lshlrev_b32 v2, 16, v10
    v_and_b32 v3, 0xffff0000, v10
    v_lshlrev_b32 v4, 16, v11
    v_and_b32 v5, 0xffff0000, v11
    v_lshlrev_b32 v6, 16, v12
    v_and_b32 v7, 0xffff0000, v12
    v_lshlrev_b32 v8, 16, v13
    v_and_b32 v9, 0xffff0000, v13
    buffer_load_dwordx4 v[98:101], v1, s[4:7], s75 offen offset:0 sc1
    buffer_load_dwordx4 v[102:105], v1, s[4:7], s79 offen offset:0 sc1
    buffer_load_dwordx4 v[106:109], v1, s[4:7], s75 offen offset:1024 sc1
    buffer_load_dwordx4 v[110:113], v1, s[4:7], s79 offen offset:1024 sc1
    buffer_load_dwordx4 v[114:117], v1, s[4:7], s75 offen offset:2048 sc1
    buffer_load_dwordx4 v[118:121], v1, s[4:7], s79 offen offset:2048 sc1
    buffer_load_dwordx4 v[122:125], v1, s[4:7], s75 offen offset:3072 sc1
    buffer_load_dwordx4 v[126:129], v1, s[4:7], s79 offen offset:3072 sc1
    s_waitcnt lgkmcnt(0)
    s_barrier
    ds_read_b128 v[194:197], v249 offset:0
    ds_read_b128 v[198:201], v249 offset:1024
    ds_read_b128 v[202:205], v249 offset:8192
    ds_read_b128 v[206:209], v249 offset:9216
    ds_read_b128 v[210:213], v249 offset:16384
    ds_read_b128 v[214:217], v249 offset:17408
    ds_read_b128 v[218:221], v249 offset:24576
    ds_read_b128 v[222:225], v249 offset:25600
    ds_read_b128 v[34:37], v249 offset:32768
    ds_read_b128 v[38:41], v249 offset:33792
    ds_read_b128 v[42:45], v249 offset:40960
    ds_read_b128 v[46:49], v249 offset:41984
    ds_read_b128 v[50:53], v249 offset:49152
    ds_read_b128 v[54:57], v249 offset:50176
    ds_read_b128 v[58:61], v249 offset:57344
    ds_read_b128 v[62:65], v249 offset:58368
    buffer_load_dwordx4 v[130:133], v1, s[4:7], s76 offen offset:0 sc1
    buffer_load_dwordx4 v[134:137], v1, s[4:7], s80 offen offset:0 sc1
    buffer_load_dwordx4 v[138:141], v1, s[4:7], s76 offen offset:1024 sc1
    buffer_load_dwordx4 v[142:145], v1, s[4:7], s80 offen offset:1024 sc1
    buffer_load_dwordx4 v[146:149], v1, s[4:7], s76 offen offset:2048 sc1
    buffer_load_dwordx4 v[150:153], v1, s[4:7], s80 offen offset:2048 sc1
    buffer_load_dwordx4 v[154:157], v1, s[4:7], s76 offen offset:3072 sc1
    buffer_load_dwordx4 v[158:161], v1, s[4:7], s80 offen offset:3072 sc1
    s_waitcnt lgkmcnt(8)
    v_pk_add_f32 v[194:195], v[194:195], v[202:203]
    v_pk_add_f32 v[196:197], v[196:197], v[204:205]
    v_pk_add_f32 v[198:199], v[198:199], v[206:207]
    v_pk_add_f32 v[200:201], v[200:201], v[208:209]
    v_pk_add_f32 v[210:211], v[210:211], v[218:219]
    v_pk_add_f32 v[212:213], v[212:213], v[220:221]
    v_pk_add_f32 v[214:215], v[214:215], v[222:223]
    v_pk_add_f32 v[216:217], v[216:217], v[224:225]
    v_pk_add_f32 v[194:195], v[194:195], v[210:211]
    v_pk_add_f32 v[196:197], v[196:197], v[212:213]
    v_pk_add_f32 v[198:199], v[198:199], v[214:215]
    v_pk_add_f32 v[200:201], v[200:201], v[216:217]
    v_pk_add_f32 v[226:227], v[226:227], v[194:195]
    v_pk_add_f32 v[228:229], v[228:229], v[196:197]
    v_pk_add_f32 v[230:231], v[230:231], v[198:199]
    v_pk_add_f32 v[232:233], v[232:233], v[200:201]
    v_cvt_pk_bf16_f32 v18, v226, v227
    v_cvt_pk_bf16_f32 v19, v228, v229
    v_cvt_pk_bf16_f32 v20, v230, v231
    v_cvt_pk_bf16_f32 v21, v232, v233
    v_accvgpr_write_b32 a224, v18
    v_accvgpr_write_b32 a225, v19
    v_accvgpr_write_b32 a226, v20
    v_accvgpr_write_b32 a227, v21
    buffer_store_dwordx4 v[18:21], v1, s[4:7], s36 offen offset:0 sc1
    s_waitcnt lgkmcnt(0)
    v_pk_add_f32 v[34:35], v[34:35], v[42:43]
    v_pk_add_f32 v[36:37], v[36:37], v[44:45]
    v_pk_add_f32 v[38:39], v[38:39], v[46:47]
    v_pk_add_f32 v[40:41], v[40:41], v[48:49]
    v_pk_add_f32 v[50:51], v[50:51], v[58:59]
    v_pk_add_f32 v[52:53], v[52:53], v[60:61]
    v_pk_add_f32 v[54:55], v[54:55], v[62:63]
    v_pk_add_f32 v[56:57], v[56:57], v[64:65]
    v_pk_add_f32 v[34:35], v[34:35], v[50:51]
    v_pk_add_f32 v[36:37], v[36:37], v[52:53]
    v_pk_add_f32 v[38:39], v[38:39], v[54:55]
    v_pk_add_f32 v[40:41], v[40:41], v[56:57]
    v_pk_add_f32 v[2:3], v[2:3], v[34:35]
    v_pk_add_f32 v[4:5], v[4:5], v[36:37]
    v_pk_add_f32 v[6:7], v[6:7], v[38:39]
    v_pk_add_f32 v[8:9], v[8:9], v[40:41]
    v_cvt_pk_bf16_f32 v22, v2, v3
    v_cvt_pk_bf16_f32 v23, v4, v5
    v_cvt_pk_bf16_f32 v24, v6, v7
    v_cvt_pk_bf16_f32 v25, v8, v9
    v_accvgpr_write_b32 a228, v22
    v_accvgpr_write_b32 a229, v23
    v_accvgpr_write_b32 a230, v24
    v_accvgpr_write_b32 a231, v25
    buffer_store_dwordx4 v[22:25], v1, s[4:7], s33 offen offset:0 sc1
    v_and_b32 v250, 15, v0
    v_lshlrev_b32 v40, 3, v250
    v_pk_add_f32 v[36:37], v[226:227], v[228:229]
    v_pk_add_f32 v[38:39], v[230:231], v[232:233]
    v_pk_add_f32 v[36:37], v[36:37], v[38:39]
    v_add_f32 v32, v36, v37
    v_pk_mul_f32 v[36:37], v[226:227], v[226:227]
    v_pk_fma_f32 v[36:37], v[228:229], v[228:229], v[36:37]
    v_pk_fma_f32 v[36:37], v[230:231], v[230:231], v[36:37]
    v_pk_fma_f32 v[36:37], v[232:233], v[232:233], v[36:37]
    v_add_f32 v33, v36, v37
    v_mov_b32 v36, v32
    v_mov_b32 v37, v33
    s_nop 0
    v_permlane32_swap_b32 v32, v36
    v_permlane32_swap_b32 v33, v37
    v_add_f32 v32, v32, v36
    v_add_f32 v33, v33, v37
    v_mov_b32 v36, v32
    v_mov_b32 v37, v33
    s_nop 0
    v_permlane16_swap_b32 v32, v36
    v_permlane16_swap_b32 v33, v37
    v_add_f32 v32, v32, v36
    v_add_f32 v33, v33, v37
    v_pk_add_f32 v[36:37], v[2:3], v[4:5]
    v_pk_add_f32 v[38:39], v[6:7], v[8:9]
    v_pk_add_f32 v[36:37], v[36:37], v[38:39]
    v_add_f32 v34, v36, v37
    v_pk_mul_f32 v[36:37], v[2:3], v[2:3]
    v_pk_fma_f32 v[36:37], v[4:5], v[4:5], v[36:37]
    v_pk_fma_f32 v[36:37], v[6:7], v[6:7], v[36:37]
    v_pk_fma_f32 v[36:37], v[8:9], v[8:9], v[36:37]
    v_add_f32 v35, v36, v37
    v_mov_b32 v36, v34
    v_mov_b32 v37, v35
    s_nop 0
    v_permlane32_swap_b32 v34, v36
    v_permlane32_swap_b32 v35, v37
    v_add_f32 v34, v34, v36
    v_add_f32 v35, v35, v37
    v_mov_b32 v36, v34
    v_mov_b32 v37, v35
    s_nop 0
    v_permlane16_swap_b32 v34, v36
    v_permlane16_swap_b32 v35, v37
    v_add_f32 v34, v34, v36
    v_add_f32 v35, v35, v37
    s_mov_b64 exec, 0xffff
    buffer_store_dwordx2 v[32:33], v40, s[4:7], s37 offen sc1
    s_add_u32 s37, s37, 3584
    buffer_store_dwordx2 v[34:35], v40, s[4:7], s37 offen sc1
    s_mov_b64 exec, -1
    v_lshlrev_b32 v236, 7, v0
    v_add_u32 v236, s28, v236
    buffer_load_dwordx4 v[162:165], v1, s[4:7], s77 offen offset:0 sc1
    buffer_load_dwordx4 v[166:169], v1, s[4:7], s81 offen offset:0 sc1
    buffer_load_dwordx4 v[170:173], v1, s[4:7], s77 offen offset:1024 sc1
    buffer_load_dwordx4 v[174:177], v1, s[4:7], s81 offen offset:1024 sc1
    v_lshrrev_b32 v251, 4, v0
    v_and_b32 v250, 15, v0
    s_mul_i32 s90, s48, 8192
    s_add_u32 s90, s90, 61440
    s_lshl_b32 s91, s42, 9
    s_add_u32 s90, s90, s91
    v_lshl_add_u32 v240, v0, 2, s90
    s_mov_b32 s94, 0x3fff3fff
    s_mov_b32 s95, 0x3fff3fff
    s_mul_i32 s20, s48, 1835008
    s_add_u32 s20, s20, 13570048
    s_mul_i32 s91, s42, 114688
    s_add_u32 s20, s20, s91
    s_lshl_b32 s91, s46, 12
    s_add_u32 s20, s20, s91
    s_add_u32 s21, s91, 86016
    s_mul_i32 s22, s48, 229376
    s_add_u32 s22, s22, 17240064
    s_lshl_b32 s91, s42, 3
    s_add_u32 s91, s91, s46
    s_mul_i32 s91, s91, 1792
    s_add_u32 s22, s22, s91
    s_add_u32 s23, s22, 7168
    s_mul_i32 s32, s48, 7340032
    s_add_u32 s32, s32, 17698816
    s_mul_i32 s91, s42, 458752
    s_add_u32 s32, s32, s91
    s_lshl_b32 s91, s41, 2
    s_add_u32 s91, s91, s46
    s_lshl_b32 s92, s91, 10
    s_add_u32 s32, s32, s92
    s_mul_i32 s33, s48, 32768
    s_add_u32 s33, s33, 77824
    s_lshl_b32 s92, s42, 11
    s_add_u32 s33, s33, s92
    s_lshl_b32 s91, s91, 2
    s_add_u32 s33, s33, s91
    v_mov_b32 v241, s33
    v_mov_b32 v242, 0x80000000
    v_cmp_eq_u32 vcc, 0, v0
    s_nop 1
    v_cndmask_b32 v241, v242, v241, vcc
    v_lshlrev_b32 v238, 3, v250
    v_lshl_add_u32 v238, v251, 7, v238
    v_mov_b32 v242, 0x80000000
    v_cmp_lt_u32 vcc, 1, v251
    s_nop 1
    v_cndmask_b32 v239, 0, v242, vcc
    v_or_b32 v239, v239, v238
    v_add_u32 v252, 86016, v1
    v_lshlrev_b32 v246, 3, v250
    v_add_u32 v246, 152064, v246
    v_mov_b32 v218, 0xc0135761
    v_mov_b32 v219, 0xc0135761
    s_mov_b32 s34, 0xbdd2d3e8
    s_mov_b32 s35, 0xbdd2d3e8
    s_lshl_b32 s90, s41, 3
    s_lshl_b32 s91, s46, 1
    s_add_u32 s90, s90, s91
    s_lshl_b32 s24, s90, 5
    v_lshlrev_b32 v248, 3, v251
    buffer_load_dwordx2 v[194:195], v248, s[12:15], s24 offen offset:0
    buffer_load_dwordx2 v[196:197], v248, s[12:15], s24 offen offset:32
    s_waitcnt vmcnt(6)
    s_mov_b64 exec, 3
    s_cmp_eq_u32 s26, 0
    s_cbranch_scc1 L_slow_13
    buffer_store_dword v254, v236, s[4:7], 0 offen
    s_branch L_st_14
L_slow_13:
    buffer_store_dword v254, v236, s[4:7], 0 offen sc1
L_st_14:
    s_mov_b64 exec, -1
    s_mov_b64 exec, s[94:95]
    s_mov_b32 s49, 0
L_poll_15:
    buffer_load_dword v253, v240, s[4:7], 0 offen sc1
    buffer_load_dword v245, v240, s[4:7], 0 offen offset:256 sc1
    s_waitcnt vmcnt(0)
    v_xor_b32 v245, s47, v245
    v_xor_b32 v253, s47, v253
    v_or_b32 v253, v253, v245
    v_cmp_ne_u32 vcc, 0, v253
    s_nop 4
    s_cbranch_vccz L_polldone_16
    s_add_u32 s49, s49, 1
    s_cmp_lt_u32 s49, 200000
    s_cbranch_scc1 L_poll_15
    s_add_u32 s99, s99, 1
L_polldone_16:
    s_mov_b64 exec, -1
    s_add_u32 s36, s20, 0
    s_add_u32 m0, s21, 0
    s_nop 0
    buffer_load_dwordx4 v1, s[4:7], s36 offen offset:0 sc1 lds
    buffer_load_dwordx4 v1, s[4:7], s36 offen offset:1024 sc1 lds
    buffer_load_dwordx4 v1, s[4:7], s36 offen offset:2048 sc1 lds
    buffer_load_dwordx4 v1, s[4:7], s36 offen offset:3072 sc1 lds
    buffer_load_dwordx2 v[198:199], v238, s[4:7], s22 offen offset:0 sc1
    buffer_load_dwordx2 v[200:201], v238, s[4:7], s22 offen offset:512 sc1
    buffer_load_dwordx2 v[202:203], v238, s[4:7], s22 offen offset:1024 sc1
    buffer_load_dwordx2 v[204:205], v239, s[4:7], s22 offen offset:1536 sc1
    buffer_load_dwordx2 v[206:207], v238, s[4:7], s23 offen offset:0 sc1
    buffer_load_dwordx2 v[208:209], v238, s[4:7], s23 offen offset:512 sc1
    buffer_load_dwordx2 v[210:211], v238, s[4:7], s23 offen offset:1024 sc1
    buffer_load_dwordx2 v[212:213], v239, s[4:7], s23 offen offset:1536 sc1
    s_add_u32 s36, s20, 57344
    s_add_u32 m0, s21, 16384
    s_nop 0
    buffer_load_dwordx4 v1, s[4:7], s36 offen offset:0 sc1 lds
    buffer_load_dwordx4 v1, s[4:7], s36 offen offset:1024 sc1 lds
    buffer_load_dwordx4 v1, s[4:7], s36 offen offset:2048 sc1 lds
    buffer_load_dwordx4 v1, s[4:7], s36 offen offset:3072 sc1 lds
    s_lshl_b32 s90, s45, 2
    s_mul_i32 s90, s90, 57344
    s_mul_i32 s91, s46, 14336
    s_add_u32 s90, s90, s91
    s_add_u32 s74, s90, 3641344
    s_add_u32 s75, s74, 4096
    s_add_u32 s76, s74, 8192
    s_add_u32 s77, s74, 12288
    s_add_u32 s78, s74, 57344
    s_add_u32 s79, s78, 4096
    s_add_u32 s80, s78, 8192
    s_add_u32 s81, s78, 12288
    s_add_u32 s82, s78, 57344
    s_add_u32 s83, s82, 4096
    s_add_u32 s84, s82, 8192
    s_add_u32 s85, s82, 12288
    s_add_u32 s86, s82, 57344
    s_add_u32 s87, s86, 4096
    s_add_u32 s88, s86, 8192
    s_add_u32 s89, s86, 12288
    s_waitcnt vmcnt(12)
    s_barrier
    s_lshl_b32 s90, s46, 7
    v_add_u32 v247, s90, v246
    s_mul_i32 s90, s48, 32768
    s_add_u32 s90, s90, 77824
    s_lshl_b32 s91, s44, 10
    s_add_u32 s90, s90, s91
    s_mul_i32 s91, s46, 56
    s_add_u32 s90, s90, s91
    v_lshl_add_u32 v243, v0, 2, s90
    s_mov_b32 s30, 0x3fff
    s_mov_b32 s31, 0
    s_mul_i32 s90, s48, 7340032
    s_add_u32 s90, s90, 17698816
    s_mul_i32 s91, s44, 229376
    s_add_u32 s90, s90, s91
    s_mul_i32 s91, s46, 14336
    s_add_u32 s25, s90, s91
    s_add_u32 s27, s25, 4096
    s_add_u32 s29, s25, 8192
    s_cmp_eq_u32 s48, 0
    s_cbranch_scc0 L_c_loop1
    ds_read_b128 v[18:21], v252 offset:0
    ds_read_b128 v[22:25], v252 offset:1024
    ds_read_b128 v[26:29], v252 offset:2048
    ds_read_b128 v[30:33], v252 offset:3072
    ds_read_b128 v[34:37], v252 offset:4096
    ds_read_b128 v[38:41], v252 offset:5120
    s_waitcnt lgkmcnt(4)
    v_mfma_f32_16x16x32_bf16 v[2:5], v[66:69], v[18:21], 0
    v_mfma_f32_16x16x32_bf16 v[178:181], v[66:69], a[240:243], 0
    s_add_u32 s36, s20, 14336
    s_add_u32 m0, s21, 32768
    v_mfma_f32_16x16x32_bf16 v[6:9], v[70:73], v[18:21], 0
    v_mfma_f32_16x16x32_bf16 v[182:185], v[70:73], a[240:243], 0
    ds_read_b128 v[42:45], v252 offset:6144
    v_mfma_f32_16x16x32_bf16 v[2:5], v[74:77], v[22:25], v[2:5]
    v_mfma_f32_16x16x32_bf16 v[178:181], v[74:77], a[240:243], v[178:181]
    buffer_load_dwordx4 v1, s[4:7], s36 offen offset:0 sc1 lds
    v_mfma_f32_16x16x32_bf16 v[6:9], v[78:81], v[22:25], v[6:9]
    v_mfma_f32_16x16x32_bf16 v[182:185], v[78:81], a[240:243], v[182:185]
    ds_read_b128 v[46:49], v252 offset:7168
    s_waitcnt lgkmcnt(4)
    v_mfma_f32_16x16x32_bf16 v[2:5], v[82:85], v[26:29], v[2:5]
    v_mfma_f32_16x16x32_bf16 v[178:181], v[82:85], a[240:243], v[178:181]
    buffer_load_dwordx4 v1, s[4:7], s36 offen offset:1024 sc1 lds
    v_mfma_f32_16x16x32_bf16 v[6:9], v[86:89], v[26:29], v[6:9]
    v_mfma_f32_16x16x32_bf16 v[182:185], v[86:89], a[240:243], v[182:185]
    ds_read_b128 v[18:21], v252 offset:8192
    v_mfma_f32_16x16x32_bf16 v[2:5], v[90:93], v[30:33], v[2:5]
    v_mfma_f32_16x16x32_bf16 v[178:181], v[90:93], a[240:243], v[178:181]
    buffer_load_dwordx4 v1, s[4:7], s36 offen offset:2048 sc1 lds
    v_mfma_f32_16x16x32_bf16 v[6:9], v[94:97], v[30:33], v[6:9]
    v_mfma_f32_16x16x32_bf16 v[182:185], v[94:97], a[240:243], v[182:185]
    ds_read_b128 v[22:25], v252 offset:9216
    s_waitcnt lgkmcnt(4)
    s_waitcnt vmcnt(7)
    v_mfma_f32_16x16x32_bf16 v[2:5], v[98:101], v[34:37], v[2:5]
    v_mfma_f32_16x16x32_bf16 v[178:181], v[98:101], a[240:243], v[178:181]
    buffer_load_dwordx4 v1, s[4:7], s36 offen offset:3072 sc1 lds
    v_add_f32 v198, v198, v200
    v_add_f32 v202, v202, v204
    v_add_f32 v198, v198, v202
    v_add_f32 v199, v199, v201
    v_mfma_f32_16x16x32_bf16 v[6:9], v[102:105], v[34:37], v[6:9]
    v_mfma_f32_16x16x32_bf16 v[182:185], v[102:105], a[240:243], v[182:185]
    ds_read_b128 v[26:29], v252 offset:10240
    v_add_f32 v203, v203, v205
    v_add_f32 v199, v199, v203
    v_mov_b32 v200, v198
    v_mfma_f32_16x16x32_bf16 v[2:5], v[106:109], v[38:41], v[2:5]
    v_mfma_f32_16x16x32_bf16 v[178:181], v[106:109], a[240:243], v[178:181]
    buffer_load_dwordx4 a[0:3], v1, s[4:7], s74 offen offset:0 sc1
    v_permlane32_swap_b32 v198, v200
    v_add_f32 v198, v198, v200
    v_mov_b32 v200, v198
    v_mfma_f32_16x16x32_bf16 v[6:9], v[110:113], v[38:41], v[6:9]
    v_mfma_f32_16x16x32_bf16 v[182:185], v[110:113], a[240:243], v[182:185]
    ds_read_b128 v[30:33], v252 offset:11264
    s_waitcnt lgkmcnt(4)
    v_permlane16_swap_b32 v198, v200
    v_add_f32 v198, v198, v200
    v_mov_b32 v201, v199
    s_nop 1
    v_permlane32_swap_b32 v199, v201
    v_mfma_f32_16x16x32_bf16 v[2:5], v[114:117], v[42:45], v[2:5]
    v_mfma_f32_16x16x32_bf16 v[178:181], v[114:117], a[240:243], v[178:181]
    buffer_load_dwordx4 a[4:7], v1, s[4:7], s78 offen offset:0 sc1
    v_add_f32 v199, v199, v201
    v_mov_b32 v201, v199
    s_nop 1
    v_permlane16_swap_b32 v199, v201
    v_mfma_f32_16x16x32_bf16 v[6:9], v[118:121], v[42:45], v[6:9]
    v_mfma_f32_16x16x32_bf16 v[182:185], v[118:121], a[240:243], v[182:185]
    ds_read_b128 v[34:37], v252 offset:12288
    buffer_load_dwordx4 a[8:11], v1, s[4:7], s82 offen offset:0 sc1
    v_add_f32 v199, v199, v201
    v_mul_f32 v198, 0x3b124925, v198
    v_mul_f32 v199, 0x3b124925, v199
    v_mfma_f32_16x16x32_bf16 v[2:5], v[122:125], v[46:49], v[2:5]
    v_mfma_f32_16x16x32_bf16 v[178:181], v[122:125], a[240:243], v[178:181]
    s_waitcnt vmcnt(7)
    s_barrier
    v_fma_f32 v199, -v198, v198, v199
    v_max_f32 v199, 0, v199
    v_add_f32 v200, 0x3727c5ac, v199
    v_rsq_f32 v200, v200
    v_mfma_f32_16x16x32_bf16 v[6:9], v[126:129], v[46:49], v[6:9]
    v_mfma_f32_16x16x32_bf16 v[182:185], v[126:129], a[240:243], v[182:185]
    ds_read_b128 v[38:41], v252 offset:13312
    s_waitcnt lgkmcnt(4)
    v_mul_f32 v199, v199, v200
    v_fmaak_f32 v199, v199, v200, 0x3727c5ac
    v_rsq_f32 v199, v199
    v_mfma_f32_16x16x32_bf16 v[2:5], v[130:133], v[18:21], v[2:5]
    v_mfma_f32_16x16x32_bf16 v[178:181], v[130:133], a[240:243], v[178:181]
    buffer_load_dwordx4 a[12:15], v1, s[4:7], s86 offen offset:0 sc1
    v_mul_f32 v199, v199, v200
    v_add_f32 v206, v206, v208
    v_add_f32 v210, v210, v212
    v_mfma_f32_16x16x32_bf16 v[6:9], v[134:137], v[18:21], v[6:9]
    v_mfma_f32_16x16x32_bf16 v[182:185], v[134:137], a[240:243], v[182:185]
    ds_read_b128 v[42:45], v252 offset:16384
    v_add_f32 v206, v206, v210
    v_add_f32 v207, v207, v209
    v_add_f32 v211, v211, v213
    v_mfma_f32_16x16x32_bf16 v[2:5], v[138:141], v[22:25], v[2:5]
    v_mfma_f32_16x16x32_bf16 v[178:181], v[138:141], a[240:243], v[178:181]
    buffer_load_dwordx4 a[16:19], v1, s[4:7], s74 offen offset:1024 sc1
    v_add_f32 v207, v207, v211
    v_mov_b32 v208, v206
    s_nop 1
    v_permlane32_swap_b32 v206, v208
    v_add_f32 v206, v206, v208
    v_mfma_f32_16x16x32_bf16 v[6:9], v[142:145], v[22:25], v[6:9]
    v_mfma_f32_16x16x32_bf16 v[182:185], v[142:145], a[240:243], v[182:185]
    ds_read_b128 v[46:49], v252 offset:17408
    s_waitcnt lgkmcnt(4)
    v_mov_b32 v208, v206
    s_nop 1
    v_permlane16_swap_b32 v206, v208
    v_add_f32 v206, v206, v208
    v_mfma_f32_16x16x32_bf16 v[2:5], v[146:149], v[26:29], v[2:5]
    v_mfma_f32_16x16x32_bf16 v[178:181], v[146:149], a[240:243], v[178:181]
    v_mov_b32 v209, v207
    s_nop 1
    v_permlane32_swap_b32 v207, v209
    v_add_f32 v207, v207, v209
    v_mfma_f32_16x16x32_bf16 v[6:9], v[150:153], v[26:29], v[6:9]
    v_mfma_f32_16x16x32_bf16 v[182:185], v[150:153], a[240:243], v[182:185]
    ds_read_b128 v[18:21], v252 offset:18432
    v_mov_b32 v209, v207
    s_nop 1
    v_permlane16_swap_b32 v207, v209
    v_add_f32 v207, v207, v209
    v_mul_f32 v206, 0x3b124925, v206
    v_mfma_f32_16x16x32_bf16 v[2:5], v[154:157], v[30:33], v[2:5]
    v_mfma_f32_16x16x32_bf16 v[178:181], v[154:157], a[240:243], v[178:181]
    buffer_load_dwordx4 a[20:23], v1, s[4:7], s78 offen offset:1024 sc1
    v_mul_f32 v207, 0x3b124925, v207
    v_fma_f32 v207, -v206, v206, v207
    v_max_f32 v207, 0, v207
    v_mfma_f32_16x16x32_bf16 v[6:9], v[158:161], v[30:33], v[6:9]
    v_mfma_f32_16x16x32_bf16 v[182:185], v[158:161], a[240:243], v[182:185]
    ds_read_b128 v[22:25], v252 offset:19456
    s_waitcnt lgkmcnt(4)
    v_add_f32 v208, 0x3727c5ac, v207
    v_rsq_f32 v208, v208
    s_nop 0
    v_mul_f32 v207, v207, v208
    v_mfma_f32_16x16x32_bf16 v[2:5], v[162:165], v[34:37], v[2:5]
    v_mfma_f32_16x16x32_bf16 v[178:181], v[162:165], a[240:243], v[178:181]
    buffer_load_dwordx4 a[24:27], v1, s[4:7], s82 offen offset:1024 sc1
    v_fmaak_f32 v207, v207, v208, 0x3727c5ac
    v_rsq_f32 v207, v207
    s_nop 0
    v_mul_f32 v207, v207, v208
    ds_write_b64 v247, v[198:199]
    v_mfma_f32_16x16x32_bf16 v[6:9], v[166:169], v[34:37], v[6:9]
    v_mfma_f32_16x16x32_bf16 v[182:185], v[166:169], a[240:243], v[182:185]
    ds_read_b128 v[26:29], v252 offset:20480
    ds_write_b64 v247, v[206:207] offset:512
    v_lshlrev_b32 v186, 16, v194
    v_and_b32 v187, 0xffff0000, v194
    v_mfma_f32_16x16x32_bf16 v[2:5], v[170:173], v[38:41], v[2:5]
    v_mfma_f32_16x16x32_bf16 v[178:181], v[170:173], a[240:243], v[178:181]
    buffer_load_dwordx4 a[28:31], v1, s[4:7], s86 offen offset:1024 sc1
    v_lshlrev_b32 v188, 16, v195
    v_and_b32 v189, 0xffff0000, v195
    v_lshlrev_b32 v190, 16, v196
    v_mfma_f32_16x16x32_bf16 v[6:9], v[174:177], v[38:41], v[6:9]
    v_mfma_f32_16x16x32_bf16 v[182:185], v[174:177], a[240:243], v[182:185]
    ds_read_b128 v[30:33], v252 offset:21504
    s_waitcnt lgkmcnt(4)
    v_and_b32 v191, 0xffff0000, v196
    v_lshlrev_b32 v192, 16, v197
    v_and_b32 v193, 0xffff0000, v197
    s_waitcnt lgkmcnt(0)
    s_barrier
    ds_read_b64 v[214:215], v246 offset:0
    v_accvgpr_write_b32 a244, v178
    v_accvgpr_write_b32 a245, v179
    v_accvgpr_write_b32 a246, v180
    v_accvgpr_write_b32 a247, v181
    v_accvgpr_write_b32 a248, v182
    v_accvgpr_write_b32 a249, v183
    v_accvgpr_write_b32 a250, v184
    v_accvgpr_write_b32 a251, v185
    s_waitcnt lgkmcnt(0)
    v_pk_fma_f32 v[2:3], v[178:179], v[214:215], v[2:3] op_sel_hi:[1,0,1] neg_lo:[0,1,0] neg_hi:[0,1,0]
    v_pk_fma_f32 v[4:5], v[180:181], v[214:215], v[4:5] op_sel_hi:[1,0,1] neg_lo:[0,1,0] neg_hi:[0,1,0]
    v_pk_fma_f32 v[6:7], v[182:183], v[214:215], v[6:7] op_sel_hi:[1,0,1] neg_lo:[0,1,0] neg_hi:[0,1,0]
    v_pk_fma_f32 v[8:9], v[184:185], v[214:215], v[8:9] op_sel_hi:[1,0,1] neg_lo:[0,1,0] neg_hi:[0,1,0]
    v_pk_fma_f32 v[2:3], v[2:3], v[214:215], v[186:187] op_sel:[0,1,0] op_sel_hi:[1,1,1]
    v_pk_fma_f32 v[4:5], v[4:5], v[214:215], v[188:189] op_sel:[0,1,0] op_sel_hi:[1,1,1]
    v_pk_fma_f32 v[6:7], v[6:7], v[214:215], v[190:191] op_sel:[0,1,0] op_sel_hi:[1,1,1]
    v_pk_fma_f32 v[8:9], v[8:9], v[214:215], v[192:193] op_sel:[0,1,0] op_sel_hi:[1,1,1]
    v_pk_mul_f32 v[50:51], v[2:3], v[2:3]
    v_pk_mul_f32 v[52:53], v[4:5], v[4:5]
    v_pk_mul_f32 v[54:55], v[6:7], v[6:7]
    v_pk_mul_f32 v[56:57], v[8:9], v[8:9]
    v_pk_fma_f32 v[50:51], v[50:51], s[34:35], v[218:219]
    v_pk_fma_f32 v[52:53], v[52:53], s[34:35], v[218:219]
    v_pk_fma_f32 v[54:55], v[54:55], s[34:35], v[218:219]
    v_pk_fma_f32 v[56:57], v[56:57], s[34:35], v[218:219]
    v_pk_mul_f32 v[50:51], v[50:51], v[2:3]
    v_pk_mul_f32 v[52:53], v[52:53], v[4:5]
    v_pk_mul_f32 v[54:55], v[54:55], v[6:7]
    v_pk_mul_f32 v[56:57], v[56:57], v[8:9]
    v_mfma_f32_16x16x32_bf16 v[10:13], v[66:69], v[42:45], 0
    s_add_u32 s36, s20, 71680
    s_add_u32 m0, s21, 49152
    s_add_u32 s22, s25, 12288
    v_exp_f32 v50, v50
    v_mfma_f32_16x16x32_bf16 v[14:17], v[70:73], v[42:45], 0
    ds_read_b128 v[34:37], v252 offset:22528
    v_mfma_f32_16x16x32_bf16 v[10:13], v[74:77], v[46:49], v[10:13]
    buffer_load_dwordx4 v1, s[4:7], s36 offen offset:0 sc1 lds
    v_exp_f32 v51, v51
    v_mfma_f32_16x16x32_bf16 v[14:17], v[78:81], v[46:49], v[14:17]
    ds_read_b128 v[38:41], v252 offset:23552
    s_waitcnt lgkmcnt(4)
    v_add_f32 v50, 1.0, v50
    v_mfma_f32_16x16x32_bf16 v[10:13], v[82:85], v[18:21], v[10:13]
    buffer_load_dwordx4 v1, s[4:7], s36 offen offset:1024 sc1 lds
    v_exp_f32 v52, v52
    v_mfma_f32_16x16x32_bf16 v[14:17], v[86:89], v[18:21], v[14:17]
    ds_read_b128 v[42:45], v252 offset:24576
    v_add_f32 v51, 1.0, v51
    v_mfma_f32_16x16x32_bf16 v[10:13], v[90:93], v[22:25], v[10:13]
    buffer_load_dwordx4 v1, s[4:7], s36 offen offset:2048 sc1 lds
    v_exp_f32 v53, v53
    v_mfma_f32_16x16x32_bf16 v[14:17], v[94:97], v[22:25], v[14:17]
    ds_read_b128 v[46:49], v252 offset:25600
    s_waitcnt lgkmcnt(4)
    v_add_f32 v52, 1.0, v52
    v_mfma_f32_16x16x32_bf16 v[10:13], v[98:101], v[26:29], v[10:13]
    buffer_load_dwordx4 v1, s[4:7], s36 offen offset:3072 sc1 lds
    v_exp_f32 v54, v54
    v_mfma_f32_16x16x32_bf16 v[14:17], v[102:105], v[26:29], v[14:17]
    ds_read_b128 v[18:21], v252 offset:26624
    v_add_f32 v53, 1.0, v53
    v_mfma_f32_16x16x32_bf16 v[10:13], v[106:109], v[30:33], v[10:13]
    buffer_load_dwordx4 a[32:35], v1, s[4:7], s74 offen offset:2048 sc1
    v_exp_f32 v55, v55
    v_mfma_f32_16x16x32_bf16 v[14:17], v[110:113], v[30:33], v[14:17]
    ds_read_b128 v[22:25], v252 offset:27648
    s_waitcnt lgkmcnt(4)
    v_add_f32 v54, 1.0, v54
    v_mfma_f32_16x16x32_bf16 v[10:13], v[114:117], v[34:37], v[10:13]
    buffer_load_dwordx4 a[36:39], v1, s[4:7], s78 offen offset:2048 sc1
    v_exp_f32 v56, v56
    v_mfma_f32_16x16x32_bf16 v[14:17], v[118:121], v[34:37], v[14:17]
    ds_read_b128 v[26:29], v252 offset:28672
    buffer_load_dwordx4 a[40:43], v1, s[4:7], s82 offen offset:2048 sc1
    v_add_f32 v55, 1.0, v55
    v_mfma_f32_16x16x32_bf16 v[10:13], v[122:125], v[38:41], v[10:13]
    s_waitcnt vmcnt(15)
    s_barrier
    v_exp_f32 v57, v57
    v_mfma_f32_16x16x32_bf16 v[14:17], v[126:129], v[38:41], v[14:17]
    ds_read_b128 v[30:33], v252 offset:29696
    s_waitcnt lgkmcnt(4)
    v_add_f32 v56, 1.0, v56
    v_mfma_f32_16x16x32_bf16 v[10:13], v[130:133], v[42:45], v[10:13]
    buffer_load_dwordx4 a[44:47], v1, s[4:7], s86 offen offset:2048 sc1
    v_rcp_f32 v50, v50
    v_mfma_f32_16x16x32_bf16 v[14:17], v[134:137], v[42:45], v[14:17]
    ds_read_b128 v[34:37], v252 offset:32768
    ds_read_b64 v[216:217], v246 offset:512
    v_add_f32 v57, 1.0, v57
    v_mfma_f32_16x16x32_bf16 v[10:13], v[138:141], v[46:49], v[10:13]
    buffer_load_dwordx4 a[48:51], v1, s[4:7], s74 offen offset:3072 sc1
    v_rcp_f32 v51, v51
    v_mfma_f32_16x16x32_bf16 v[14:17], v[142:145], v[46:49], v[14:17]
    ds_read_b128 v[38:41], v252 offset:33792
    s_waitcnt lgkmcnt(4)
    v_mfma_f32_16x16x32_bf16 v[10:13], v[146:149], v[18:21], v[10:13]
    v_rcp_f32 v52, v52
    v_mfma_f32_16x16x32_bf16 v[14:17], v[150:153], v[18:21], v[14:17]
    ds_read_b128 v[42:45], v252 offset:34816
    v_mfma_f32_16x16x32_bf16 v[10:13], v[154:157], v[22:25], v[10:13]
    buffer_load_dwordx4 a[52:55], v1, s[4:7], s78 offen offset:3072 sc1
    v_rcp_f32 v53, v53
    v_mfma_f32_16x16x32_bf16 v[14:17], v[158:161], v[22:25], v[14:17]
    ds_read_b128 v[46:49], v252 offset:35840
    s_waitcnt lgkmcnt(4)
    v_mfma_f32_16x16x32_bf16 v[10:13], v[162:165], v[26:29], v[10:13]
    buffer_load_dwordx4 a[56:59], v1, s[4:7], s82 offen offset:3072 sc1
    v_rcp_f32 v54, v54
    v_mfma_f32_16x16x32_bf16 v[14:17], v[166:169], v[26:29], v[14:17]
    ds_read_b128 v[18:21], v252 offset:36864
    v_rcp_f32 v56, v56
    v_mfma_f32_16x16x32_bf16 v[10:13], v[170:173], v[30:33], v[10:13]
    buffer_load_dwordx4 a[60:63], v1, s[4:7], s86 offen offset:3072 sc1
    v_rcp_f32 v55, v55
    v_mfma_f32_16x16x32_bf16 v[14:17], v[174:177], v[30:33], v[14:17]
    ds_read_b128 v[22:25], v252 offset:37888
    s_waitcnt lgkmcnt(4)
    v_rcp_f32 v57, v57
    v_pk_mul_f32 v[50:51], v[50:51], v[2:3]
    v_pk_mul_f32 v[52:53], v[52:53], v[4:5]
    v_pk_mul_f32 v[54:55], v[54:55], v[6:7]
    v_pk_mul_f32 v[56:57], v[56:57], v[8:9]
    v_cvt_pk_bf16_f32 v58, v50, v51
    v_cvt_pk_bf16_f32 v59, v52, v53
    v_cvt_pk_bf16_f32 v60, v54, v55
    v_cvt_pk_bf16_f32 v61, v56, v57
    s_add_u32 s24, s32, 0
    buffer_store_dwordx4 v[58:61], v1, s[4:7], s24 offen sc1
    v_pk_fma_f32 v[10:11], v[178:179], v[216:217], v[10:11] op_sel_hi:[1,0,1] neg_lo:[0,1,0] neg_hi:[0,1,0]
    v_pk_fma_f32 v[12:13], v[180:181], v[216:217], v[12:13] op_sel_hi:[1,0,1] neg_lo:[0,1,0] neg_hi:[0,1,0]
    v_pk_fma_f32 v[14:15], v[182:183], v[216:217], v[14:15] op_sel_hi:[1,0,1] neg_lo:[0,1,0] neg_hi:[0,1,0]
    v_pk_fma_f32 v[16:17], v[184:185], v[216:217], v[16:17] op_sel_hi:[1,0,1] neg_lo:[0,1,0] neg_hi:[0,1,0]
    v_pk_fma_f32 v[10:11], v[10:11], v[216:217], v[186:187] op_sel:[0,1,0] op_sel_hi:[1,1,1]
    v_pk_fma_f32 v[12:13], v[12:13], v[216:217], v[188:189] op_sel:[0,1,0] op_sel_hi:[1,1,1]
    v_pk_fma_f32 v[14:15], v[14:15], v[216:217], v[190:191] op_sel:[0,1,0] op_sel_hi:[1,1,1]
    v_pk_fma_f32 v[16:17], v[16:17], v[216:217], v[192:193] op_sel:[0,1,0] op_sel_hi:[1,1,1]
    v_pk_mul_f32 v[50:51], v[10:11], v[10:11]
    v_pk_mul_f32 v[52:53], v[12:13], v[12:13]
    v_pk_mul_f32 v[54:55], v[14:15], v[14:15]
    v_pk_mul_f32 v[56:57], v[16:17], v[16:17]
    v_pk_fma_f32 v[50:51], v[50:51], s[34:35], v[218:219]
    v_pk_fma_f32 v[52:53], v[52:53], s[34:35], v[218:219]
    v_pk_fma_f32 v[54:55], v[54:55], s[34:35], v[218:219]
    v_pk_fma_f32 v[56:57], v[56:57], s[34:35], v[218:219]
    v_pk_mul_f32 v[50:51], v[50:51], v[10:11]
    v_pk_mul_f32 v[52:53], v[52:53], v[12:13]
    v_pk_mul_f32 v[54:55], v[54:55], v[14:15]
    v_pk_mul_f32 v[56:57], v[56:57], v[16:17]
    v_mfma_f32_16x16x32_bf16 v[2:5], v[66:69], v[34:37], 0
    s_add_u32 s36, s20, 28672
    s_add_u32 m0, s21, 0
    v_exp_f32 v50, v50
    v_mfma_f32_16x16x32_bf16 v[6:9], v[70:73], v[34:37], 0
    ds_read_b128 v[26:29], v252 offset:38912
    v_mfma_f32_16x16x32_bf16 v[2:5], v[74:77], v[38:41], v[2:5]
    buffer_load_dwordx4 v1, s[4:7], s36 offen offset:0 sc1 lds
    v_exp_f32 v51, v51
    v_mfma_f32_16x16x32_bf16 v[6:9], v[78:81], v[38:41], v[6:9]
    ds_read_b128 v[30:33], v252 offset:39936
    s_waitcnt lgkmcnt(4)
    v_add_f32 v50, 1.0, v50
    v_mfma_f32_16x16x32_bf16 v[2:5], v[82:85], v[42:45], v[2:5]
    buffer_load_dwordx4 v1, s[4:7], s36 offen offset:1024 sc1 lds
    v_exp_f32 v52, v52
    v_mfma_f32_16x16x32_bf16 v[6:9], v[86:89], v[42:45], v[6:9]
    ds_read_b128 v[34:37], v252 offset:40960
    v_add_f32 v51, 1.0, v51
    v_mfma_f32_16x16x32_bf16 v[2:5], v[90:93], v[46:49], v[2:5]
    buffer_load_dwordx4 v1, s[4:7], s36 offen offset:2048 sc1 lds
    v_exp_f32 v53, v53
    v_mfma_f32_16x16x32_bf16 v[6:9], v[94:97], v[46:49], v[6:9]
    ds_read_b128 v[38:41], v252 offset:41984
    s_waitcnt lgkmcnt(4)
    v_add_f32 v52, 1.0, v52
    v_mfma_f32_16x16x32_bf16 v[2:5], v[98:101], v[18:21], v[2:5]
    buffer_load_dwordx4 v1, s[4:7], s36 offen offset:3072 sc1 lds
    v_exp_f32 v54, v54
    v_mfma_f32_16x16x32_bf16 v[6:9], v[102:105], v[18:21], v[6:9]
    ds_read_b128 v[42:45], v252 offset:43008
    v_add_f32 v53, 1.0, v53
    v_mfma_f32_16x16x32_bf16 v[2:5], v[106:109], v[22:25], v[2:5]
    buffer_load_dwordx4 a[64:67], v1, s[4:7], s75 offen offset:0 sc1
    v_exp_f32 v55, v55
    v_mfma_f32_16x16x32_bf16 v[6:9], v[110:113], v[22:25], v[6:9]
    ds_read_b128 v[46:49], v252 offset:44032
    s_waitcnt lgkmcnt(4)
    v_add_f32 v54, 1.0, v54
    v_mfma_f32_16x16x32_bf16 v[2:5], v[114:117], v[26:29], v[2:5]
    buffer_load_dwordx4 a[68:71], v1, s[4:7], s79 offen offset:0 sc1
    v_exp_f32 v56, v56
    v_mfma_f32_16x16x32_bf16 v[6:9], v[118:121], v[26:29], v[6:9]
    ds_read_b128 v[18:21], v252 offset:45056
    buffer_load_dwordx4 a[72:75], v1, s[4:7], s83 offen offset:0 sc1
    v_add_f32 v55, 1.0, v55
    v_mfma_f32_16x16x32_bf16 v[2:5], v[122:125], v[30:33], v[2:5]
    s_waitcnt vmcnt(16)
    s_barrier
    v_exp_f32 v57, v57
    v_mfma_f32_16x16x32_bf16 v[6:9], v[126:129], v[30:33], v[6:9]
    ds_read_b128 v[22:25], v252 offset:46080
    s_waitcnt lgkmcnt(4)
    v_add_f32 v56, 1.0, v56
    v_mfma_f32_16x16x32_bf16 v[2:5], v[130:133], v[34:37], v[2:5]
    buffer_load_dwordx4 a[76:79], v1, s[4:7], s87 offen offset:0 sc1
    v_rcp_f32 v50, v50
    v_mfma_f32_16x16x32_bf16 v[6:9], v[134:137], v[34:37], v[6:9]
    ds_read_b128 v[26:29], v252 offset:49152
    ds_read_b64 v[214:215], v246 offset:128
    v_add_f32 v57, 1.0, v57
    v_mfma_f32_16x16x32_bf16 v[2:5], v[138:141], v[38:41], v[2:5]
    buffer_load_dwordx4 a[80:83], v1, s[4:7], s75 offen offset:1024 sc1
    v_rcp_f32 v51, v51
    v_mfma_f32_16x16x32_bf16 v[6:9], v[142:145], v[38:41], v[6:9]
    ds_read_b128 v[30:33], v252 offset:50176
    s_waitcnt lgkmcnt(4)
    v_mfma_f32_16x16x32_bf16 v[2:5], v[146:149], v[42:45], v[2:5]
    v_rcp_f32 v52, v52
    v_mfma_f32_16x16x32_bf16 v[6:9], v[150:153], v[42:45], v[6:9]
    ds_read_b128 v[34:37], v252 offset:51200
    v_mfma_f32_16x16x32_bf16 v[2:5], v[154:157], v[46:49], v[2:5]
    buffer_load_dwordx4 a[84:87], v1, s[4:7], s79 offen offset:1024 sc1
    v_rcp_f32 v53, v53
    v_mfma_f32_16x16x32_bf16 v[6:9], v[158:161], v[46:49], v[6:9]
    ds_read_b128 v[38:41], v252 offset:52224
    s_waitcnt lgkmcnt(4)
    v_mfma_f32_16x16x32_bf16 v[2:5], v[162:165], v[18:21], v[2:5]
    buffer_load_dwordx4 a[88:91], v1, s[4:7], s83 offen offset:1024 sc1
    v_rcp_f32 v54, v54
    v_mfma_f32_16x16x32_bf16 v[6:9], v[166:169], v[18:21], v[6:9]
    ds_read_b128 v[42:45], v252 offset:53248
    v_rcp_f32 v56, v56
    v_mfma_f32_16x16x32_bf16 v[2:5], v[170:173], v[22:25], v[2:5]
    buffer_load_dwordx4 a[92:95], v1, s[4:7], s87 offen offset:1024 sc1
    v_rcp_f32 v55, v55
    v_mfma_f32_16x16x32_bf16 v[6:9], v[174:177], v[22:25], v[6:9]
    ds_read_b128 v[46:49], v252 offset:54272
    s_waitcnt lgkmcnt(4)
    v_rcp_f32 v57, v57
    v_pk_mul_f32 v[50:51], v[50:51], v[10:11]
    v_pk_mul_f32 v[52:53], v[52:53], v[12:13]
    v_pk_mul_f32 v[54:55], v[54:55], v[14:15]
    v_pk_mul_f32 v[56:57], v[56:57], v[16:17]
    v_cvt_pk_bf16_f32 v62, v50, v51
    v_cvt_pk_bf16_f32 v63, v52, v53
    v_cvt_pk_bf16_f32 v64, v54, v55
    v_cvt_pk_bf16_f32 v65, v56, v57
    s_add_u32 s24, s32, 229376
    buffer_store_dwordx4 v[62:65], v1, s[4:7], s24 offen sc1
    v_pk_fma_f32 v[2:3], v[178:179], v[214:215], v[2:3] op_sel_hi:[1,0,1] neg_lo:[0,1,0] neg_hi:[0,1,0]
    v_pk_fma_f32 v[4:5], v[180:181], v[214:215], v[4:5] op_sel_hi:[1,0,1] neg_lo:[0,1,0] neg_hi:[0,1,0]
    v_pk_fma_f32 v[6:7], v[182:183], v[214:215], v[6:7] op_sel_hi:[1,0,1] neg_lo:[0,1,0] neg_hi:[0,1,0]
    v_pk_fma_f32 v[8:9], v[184:185], v[214:215], v[8:9] op_sel_hi:[1,0,1] neg_lo:[0,1,0] neg_hi:[0,1,0]
    v_pk_fma_f32 v[2:3], v[2:3], v[214:215], v[186:187] op_sel:[0,1,0] op_sel_hi:[1,1,1]
    v_pk_fma_f32 v[4:5], v[4:5], v[214:215], v[188:189] op_sel:[0,1,0] op_sel_hi:[1,1,1]
    v_pk_fma_f32 v[6:7], v[6:7], v[214:215], v[190:191] op_sel:[0,1,0] op_sel_hi:[1,1,1]
    v_pk_fma_f32 v[8:9], v[8:9], v[214:215], v[192:193] op_sel:[0,1,0] op_sel_hi:[1,1,1]
    v_pk_mul_f32 v[50:51], v[2:3], v[2:3]
    v_pk_mul_f32 v[52:53], v[4:5], v[4:5]
    v_pk_mul_f32 v[54:55], v[6:7], v[6:7]
    v_pk_mul_f32 v[56:57], v[8:9], v[8:9]
    v_pk_fma_f32 v[50:51], v[50:51], s[34:35], v[218:219]
    v_pk_fma_f32 v[52:53], v[52:53], s[34:35], v[218:219]
    v_pk_fma_f32 v[54:55], v[54:55], s[34:35], v[218:219]
    v_pk_fma_f32 v[56:57], v[56:57], s[34:35], v[218:219]
    v_pk_mul_f32 v[50:51], v[50:51], v[2:3]
    v_pk_mul_f32 v[52:53], v[52:53], v[4:5]
    v_pk_mul_f32 v[54:55], v[54:55], v[6:7]
    v_pk_mul_f32 v[56:57], v[56:57], v[8:9]
    v_mfma_f32_16x16x32_bf16 v[10:13], v[66:69], v[26:29], 0
    s_add_u32 s36, s20, 86016
    s_add_u32 m0, s21, 16384
    v_exp_f32 v50, v50
    v_mfma_f32_16x16x32_bf16 v[14:17], v[70:73], v[26:29], 0
    ds_read_b128 v[18:21], v252 offset:55296
    v_mfma_f32_16x16x32_bf16 v[10:13], v[74:77], v[30:33], v[10:13]
    buffer_load_dwordx4 v1, s[4:7], s36 offen offset:0 sc1 lds
    v_exp_f32 v51, v51
    v_mfma_f32_16x16x32_bf16 v[14:17], v[78:81], v[30:33], v[14:17]
    ds_read_b128 v[22:25], v252 offset:56320
    s_waitcnt lgkmcnt(4)
    v_add_f32 v50, 1.0, v50
    v_mfma_f32_16x16x32_bf16 v[10:13], v[82:85], v[34:37], v[10:13]
    buffer_load_dwordx4 v1, s[4:7], s36 offen offset:1024 sc1 lds
    v_exp_f32 v52, v52
    v_mfma_f32_16x16x32_bf16 v[14:17], v[86:89], v[34:37], v[14:17]
    ds_read_b128 v[26:29], v252 offset:57344
    v_add_f32 v51, 1.0, v51
    v_mfma_f32_16x16x32_bf16 v[10:13], v[90:93], v[38:41], v[10:13]
    buffer_load_dwordx4 v1, s[4:7], s36 offen offset:2048 sc1 lds
    v_exp_f32 v53, v53
    v_mfma_f32_16x16x32_bf16 v[14:17], v[94:97], v[38:41], v[14:17]
    ds_read_b128 v[30:33], v252 offset:58368
    s_waitcnt lgkmcnt(4)
    v_add_f32 v52, 1.0, v52
    v_mfma_f32_16x16x32_bf16 v[10:13], v[98:101], v[42:45], v[10:13]
    buffer_load_dwordx4 v1, s[4:7], s36 offen offset:3072 sc1 lds
    v_exp_f32 v54, v54
    v_mfma_f32_16x16x32_bf16 v[14:17], v[102:105], v[42:45], v[14:17]
    ds_read_b128 v[34:37], v252 offset:59392
    v_add_f32 v53, 1.0, v53
    v_mfma_f32_16x16x32_bf16 v[10:13], v[106:109], v[46:49], v[10:13]
    buffer_load_dwordx4 a[96:99], v1, s[4:7], s75 offen offset:2048 sc1
    v_exp_f32 v55, v55
    v_mfma_f32_16x16x32_bf16 v[14:17], v[110:113], v[46:49], v[14:17]
    ds_read_b128 v[38:41], v252 offset:60416
    s_waitcnt lgkmcnt(4)
    v_add_f32 v54, 1.0, v54
    v_mfma_f32_16x16x32_bf16 v[10:13], v[114:117], v[18:21], v[10:13]
    buffer_load_dwordx4 a[100:103], v1, s[4:7], s79 offen offset:2048 sc1
    v_exp_f32 v56, v56
    v_mfma_f32_16x16x32_bf16 v[14:17], v[118:121], v[18:21], v[14:17]
    ds_read_b128 v[42:45], v252 offset:61440
    buffer_load_dwordx4 a[104:107], v1, s[4:7], s83 offen offset:2048 sc1
    v_add_f32 v55, 1.0, v55
    v_mfma_f32_16x16x32_bf16 v[10:13], v[122:125], v[22:25], v[10:13]
    s_waitcnt vmcnt(16)
    s_barrier
    v_exp_f32 v57, v57
    v_mfma_f32_16x16x32_bf16 v[14:17], v[126:129], v[22:25], v[14:17]
    ds_read_b128 v[46:49], v252 offset:62464
    s_waitcnt lgkmcnt(4)
    v_add_f32 v56, 1.0, v56
    v_mfma_f32_16x16x32_bf16 v[10:13], v[130:133], v[26:29], v[10:13]
    buffer_load_dwordx4 a[108:111], v1, s[4:7], s87 offen offset:2048 sc1
    v_rcp_f32 v50, v50
    v_mfma_f32_16x16x32_bf16 v[14:17], v[134:137], v[26:29], v[14:17]
    ds_read_b128 v[18:21], v252 offset:0
    ds_read_b64 v[216:217], v246 offset:640
    v_add_f32 v57, 1.0, v57
    v_mfma_f32_16x16x32_bf16 v[10:13], v[138:141], v[30:33], v[10:13]
    buffer_load_dwordx4 a[112:115], v1, s[4:7], s75 offen offset:3072 sc1
    v_rcp_f32 v51, v51
    v_mfma_f32_16x16x32_bf16 v[14:17], v[142:145], v[30:33], v[14:17]
    ds_read_b128 v[22:25], v252 offset:1024
    s_waitcnt lgkmcnt(4)
    v_mfma_f32_16x16x32_bf16 v[10:13], v[146:149], v[34:37], v[10:13]
    s_waitcnt vmcnt(22)
    s_cmp_eq_u32 s101, 0
    s_cbranch_scc1 L_slow_17
    buffer_store_dword v254, v241, s[4:7], 0 offen offset:0
    s_branch L_st_18
L_slow_17:
    buffer_store_dword v254, v241, s[4:7], 0 offen offset:0 sc1
L_st_18:
    v_rcp_f32 v52, v52
    v_mfma_f32_16x16x32_bf16 v[14:17], v[150:153], v[34:37], v[14:17]
    ds_read_b128 v[26:29], v252 offset:2048
    v_mfma_f32_16x16x32_bf16 v[10:13], v[154:157], v[38:41], v[10:13]
    buffer_load_dwordx4 a[116:119], v1, s[4:7], s79 offen offset:3072 sc1
    v_rcp_f32 v53, v53
    v_mfma_f32_16x16x32_bf16 v[14:17], v[158:161], v[38:41], v[14:17]
    ds_read_b128 v[30:33], v252 offset:3072
    s_waitcnt lgkmcnt(4)
    v_mfma_f32_16x16x32_bf16 v[10:13], v[162:165], v[42:45], v[10:13]
    buffer_load_dwordx4 a[120:123], v1, s[4:7], s83 offen offset:3072 sc1
    v_rcp_f32 v54, v54
    v_mfma_f32_16x16x32_bf16 v[14:17], v[166:169], v[42:45], v[14:17]
    ds_read_b128 v[34:37], v252 offset:4096
    v_rcp_f32 v56, v56
    v_mfma_f32_16x16x32_bf16 v[10:13], v[170:173], v[46:49], v[10:13]
    buffer_load_dwordx4 a[124:127], v1, s[4:7], s87 offen offset:3072 sc1
    v_rcp_f32 v55, v55
    v_mfma_f32_16x16x32_bf16 v[14:17], v[174:177], v[46:49], v[14:17]
    ds_read_b128 v[38:41], v252 offset:5120
    s_waitcnt lgkmcnt(4)
    v_rcp_f32 v57, v57
    v_pk_mul_f32 v[50:51], v[50:51], v[2:3]
    v_pk_mul_f32 v[52:53], v[52:53], v[4:5]
    v_pk_mul_f32 v[54:55], v[54:55], v[6:7]
    v_pk_mul_f32 v[56:57], v[56:57], v[8:9]
    v_cvt_pk_bf16_f32 v58, v50, v51
    v_cvt_pk_bf16_f32 v59, v52, v53
    v_cvt_pk_bf16_f32 v60, v54, v55
    v_cvt_pk_bf16_f32 v61, v56, v57
    s_add_u32 s24, s32, 57344
    buffer_store_dwordx4 v[58:61], v1, s[4:7], s24 offen sc1
    v_pk_fma_f32 v[10:11], v[178:179], v[216:217], v[10:11] op_sel_hi:[1,0,1] neg_lo:[0,1,0] neg_hi:[0,1,0]
    v_pk_fma_f32 v[12:13], v[180:181], v[216:217], v[12:13] op_sel_hi:[1,0,1] neg_lo:[0,1,0] neg_hi:[0,1,0]
    v_pk_fma_f32 v[14:15], v[182:183], v[216:217], v[14:15] op_sel_hi:[1,0,1] neg_lo:[0,1,0] neg_hi:[0,1,0]
    v_pk_fma_f32 v[16:17], v[184:185], v[216:217], v[16:17] op_sel_hi:[1,0,1] neg_lo:[0,1,0] neg_hi:[0,1,0]
    v_pk_fma_f32 v[10:11], v[10:11], v[216:217], v[186:187] op_sel:[0,1,0] op_sel_hi:[1,1,1]
    v_pk_fma_f32 v[12:13], v[12:13], v[216:217], v[188:189] op_sel:[0,1,0] op_sel_hi:[1,1,1]
    v_pk_fma_f32 v[14:15], v[14:15], v[216:217], v[190:191] op_sel:[0,1,0] op_sel_hi:[1,1,1]
    v_pk_fma_f32 v[16:17], v[16:17], v[216:217], v[192:193] op_sel:[0,1,0] op_sel_hi:[1,1,1]
    v_pk_mul_f32 v[50:51], v[10:11], v[10:11]
    v_pk_mul_f32 v[52:53], v[12:13], v[12:13]
    v_pk_mul_f32 v[54:55], v[14:15], v[14:15]
    v_pk_mul_f32 v[56:57], v[16:17], v[16:17]
    v_pk_fma_f32 v[50:51], v[50:51], s[34:35], v[218:219]
    v_pk_fma_f32 v[52:53], v[52:53], s[34:35], v[218:219]
    v_pk_fma_f32 v[54:55], v[54:55], s[34:35], v[218:219]
    v_pk_fma_f32 v[56:57], v[56:57], s[34:35], v[218:219]
    v_pk_mul_f32 v[50:51], v[50:51], v[10:11]
    v_pk_mul_f32 v[52:53], v[52:53], v[12:13]
    v_pk_mul_f32 v[54:55], v[54:55], v[14:15]
    v_pk_mul_f32 v[56:57], v[56:57], v[16:17]
    v_mfma_f32_16x16x32_bf16 v[2:5], v[66:69], v[18:21], 0
    s_add_u32 s36, s20, 43008
    s_add_u32 m0, s21, 32768
    v_exp_f32 v50, v50
    v_mfma_f32_16x16x32_bf16 v[6:9], v[70:73], v[18:21], 0
    ds_read_b128 v[42:45], v252 offset:6144
    v_mfma_f32_16x16x32_bf16 v[2:5], v[74:77], v[22:25], v[2:5]
    buffer_load_dwordx4 v1, s[4:7], s36 offen offset:0 sc1 lds
    v_exp_f32 v51, v51
    v_mfma_f32_16x16x32_bf16 v[6:9], v[78:81], v[22:25], v[6:9]
    ds_read_b128 v[46:49], v252 offset:7168
    s_waitcnt lgkmcnt(4)
    v_add_f32 v50, 1.0, v50
    v_mfma_f32_16x16x32_bf16 v[2:5], v[82:85], v[26:29], v[2:5]
    buffer_load_dwordx4 v1, s[4:7], s36 offen offset:1024 sc1 lds
    v_exp_f32 v52, v52
    v_mfma_f32_16x16x32_bf16 v[6:9], v[86:89], v[26:29], v[6:9]
    ds_read_b128 v[18:21], v252 offset:8192
    v_add_f32 v51, 1.0, v51
    v_mfma_f32_16x16x32_bf16 v[2:5], v[90:93], v[30:33], v[2:5]
    buffer_load_dwordx4 v1, s[4:7], s36 offen offset:2048 sc1 lds
    v_exp_f32 v53, v53
    v_mfma_f32_16x16x32_bf16 v[6:9], v[94:97], v[30:33], v[6:9]
    ds_read_b128 v[22:25], v252 offset:9216
    s_waitcnt lgkmcnt(4)
    v_add_f32 v52, 1.0, v52
    v_mfma_f32_16x16x32_bf16 v[2:5], v[98:101], v[34:37], v[2:5]
    buffer_load_dwordx4 v1, s[4:7], s36 offen offset:3072 sc1 lds
    v_exp_f32 v54, v54
    v_mfma_f32_16x16x32_bf16 v[6:9], v[102:105], v[34:37], v[6:9]
    ds_read_b128 v[26:29], v252 offset:10240
    v_add_f32 v53, 1.0, v53
    v_mfma_f32_16x16x32_bf16 v[2:5], v[106:109], v[38:41], v[2:5]
    buffer_load_dwordx4 a[128:131], v1, s[4:7], s76 offen offset:0 sc1
    v_exp_f32 v55, v55
    v_mfma_f32_16x16x32_bf16 v[6:9], v[110:113], v[38:41], v[6:9]
    ds_read_b128 v[30:33], v252 offset:11264
    s_waitcnt lgkmcnt(4)
    v_add_f32 v54, 1.0, v54
    v_mfma_f32_16x16x32_bf16 v[2:5], v[114:117], v[42:45], v[2:5]
    buffer_load_dwordx4 a[132:135], v1, s[4:7], s80 offen offset:0 sc1
    v_exp_f32 v56, v56
    v_mfma_f32_16x16x32_bf16 v[6:9], v[118:121], v[42:45], v[6:9]
    ds_read_b128 v[34:37], v252 offset:12288
    buffer_load_dwordx4 a[136:139], v1, s[4:7], s84 offen offset:0 sc1
    v_add_f32 v55, 1.0, v55
    v_mfma_f32_16x16x32_bf16 v[2:5], v[122:125], v[46:49], v[2:5]
    s_waitcnt vmcnt(17)
    s_barrier
    v_exp_f32 v57, v57
    v_mfma_f32_16x16x32_bf16 v[6:9], v[126:129], v[46:49], v[6:9]
    ds_read_b128 v[38:41], v252 offset:13312
    s_waitcnt lgkmcnt(4)
    v_add_f32 v56, 1.0, v56
    v_mfma_f32_16x16x32_bf16 v[2:5], v[130:133], v[18:21], v[2:5]
    buffer_load_dwordx4 a[140:143], v1, s[4:7], s88 offen offset:0 sc1
    v_rcp_f32 v50, v50
    v_mfma_f32_16x16x32_bf16 v[6:9], v[134:137], v[18:21], v[6:9]
    ds_read_b128 v[42:45], v252 offset:16384
    ds_read_b64 v[214:215], v246 offset:256
    v_add_f32 v57, 1.0, v57
    v_mfma_f32_16x16x32_bf16 v[2:5], v[138:141], v[22:25], v[2:5]
    buffer_load_dwordx4 a[144:147], v1, s[4:7], s76 offen offset:1024 sc1
    v_rcp_f32 v51, v51
    v_mfma_f32_16x16x32_bf16 v[6:9], v[142:145], v[22:25], v[6:9]
    ds_read_b128 v[46:49], v252 offset:17408
    s_waitcnt lgkmcnt(4)
    v_mfma_f32_16x16x32_bf16 v[2:5], v[146:149], v[26:29], v[2:5]
    s_waitcnt vmcnt(23)
    s_cmp_eq_u32 s101, 0
    s_cbranch_scc1 L_slow_19
    buffer_store_dword v254, v241, s[4:7], 0 offen offset:1024
    s_branch L_st_20
L_slow_19:
    buffer_store_dword v254, v241, s[4:7], 0 offen offset:1024 sc1
L_st_20:
    v_rcp_f32 v52, v52
    v_mfma_f32_16x16x32_bf16 v[6:9], v[150:153], v[26:29], v[6:9]
    ds_read_b128 v[18:21], v252 offset:18432
    v_mfma_f32_16x16x32_bf16 v[2:5], v[154:157], v[30:33], v[2:5]
    buffer_load_dwordx4 a[148:151], v1, s[4:7], s80 offen offset:1024 sc1
    v_rcp_f32 v53, v53
    v_mfma_f32_16x16x32_bf16 v[6:9], v[158:161], v[30:33], v[6:9]
    ds_read_b128 v[22:25], v252 offset:19456
    s_waitcnt lgkmcnt(4)
    v_mfma_f32_16x16x32_bf16 v[2:5], v[162:165], v[34:37], v[2:5]
    buffer_load_dwordx4 a[152:155], v1, s[4:7], s84 offen offset:1024 sc1
    v_rcp_f32 v54, v54
    v_mfma_f32_16x16x32_bf16 v[6:9], v[166:169], v[34:37], v[6:9]
    ds_read_b128 v[26:29], v252 offset:20480
    v_rcp_f32 v56, v56
    v_mfma_f32_16x16x32_bf16 v[2:5], v[170:173], v[38:41], v[2:5]
    buffer_load_dwordx4 a[156:159], v1, s[4:7], s88 offen offset:1024 sc1
    v_rcp_f32 v55, v55
    v_mfma_f32_16x16x32_bf16 v[6:9], v[174:177], v[38:41], v[6:9]
    ds_read_b128 v[30:33], v252 offset:21504
    s_waitcnt lgkmcnt(4)
    v_rcp_f32 v57, v57
    v_pk_mul_f32 v[50:51], v[50:51], v[10:11]
    v_pk_mul_f32 v[52:53], v[52:53], v[12:13]
    v_pk_mul_f32 v[54:55], v[54:55], v[14:15]
    v_pk_mul_f32 v[56:57], v[56:57], v[16:17]
    v_cvt_pk_bf16_f32 v62, v50, v51
    v_cvt_pk_bf16_f32 v63, v52, v53
    v_cvt_pk_bf16_f32 v64, v54, v55
    v_cvt_pk_bf16_f32 v65, v56, v57
    s_add_u32 s24, s32, 286720
    buffer_store_dwordx4 v[62:65], v1, s[4:7], s24 offen sc1
    v_pk_fma_f32 v[2:3], v[178:179], v[214:215], v[2:3] op_sel_hi:[1,0,1] neg_lo:[0,1,0] neg_hi:[0,1,0]
    v_pk_fma_f32 v[4:5], v[180:181], v[214:215], v[4:5] op_sel_hi:[1,0,1] neg_lo:[0,1,0] neg_hi:[0,1,0]
    v_pk_fma_f32 v[6:7], v[182:183], v[214:215], v[6:7] op_sel_hi:[1,0,1] neg_lo:[0,1,0] neg_hi:[0,1,0]
    v_pk_fma_f32 v[8:9], v[184:185], v[214:215], v[8:9] op_sel_hi:[1,0,1] neg_lo:[0,1,0] neg_hi:[0,1,0]
    v_pk_fma_f32 v[2:3], v[2:3], v[214:215], v[186:187] op_sel:[0,1,0] op_sel_hi:[1,1,1]
    v_pk_fma_f32 v[4:5], v[4:5], v[214:215], v[188:189] op_sel:[0,1,0] op_sel_hi:[1,1,1]
    v_pk_fma_f32 v[6:7], v[6:7], v[214:215], v[190:191] op_sel:[0,1,0] op_sel_hi:[1,1,1]
    v_pk_fma_f32 v[8:9], v[8:9], v[214:215], v[192:193] op_sel:[0,1,0] op_sel_hi:[1,1,1]
    v_pk_mul_f32 v[50:51], v[2:3], v[2:3]
    v_pk_mul_f32 v[52:53], v[4:5], v[4:5]
    v_pk_mul_f32 v[54:55], v[6:7], v[6:7]
    v_pk_mul_f32 v[56:57], v[8:9], v[8:9]
    v_pk_fma_f32 v[50:51], v[50:51], s[34:35], v[218:219]
    v_pk_fma_f32 v[52:53], v[52:53], s[34:35], v[218:219]
    v_pk_fma_f32 v[54:55], v[54:55], s[34:35], v[218:219]
    v_pk_fma_f32 v[56:57], v[56:57], s[34:35], v[218:219]
    v_pk_mul_f32 v[50:51], v[50:51], v[2:3]
    v_pk_mul_f32 v[52:53], v[52:53], v[4:5]
    v_pk_mul_f32 v[54:55], v[54:55], v[6:7]
    v_pk_mul_f32 v[56:57], v[56:57], v[8:9]
    v_mfma_f32_16x16x32_bf16 v[10:13], v[66:69], v[42:45], 0
    s_add_u32 s36, s20, 100352
    s_add_u32 m0, s21, 49152
    v_exp_f32 v50, v50
    v_mfma_f32_16x16x32_bf16 v[14:17], v[70:73], v[42:45], 0
    ds_read_b128 v[34:37], v252 offset:22528
    v_mfma_f32_16x16x32_bf16 v[10:13], v[74:77], v[46:49], v[10:13]
    buffer_load_dwordx4 v1, s[4:7], s36 offen offset:0 sc1 lds
    v_exp_f32 v51, v51
    v_mfma_f32_16x16x32_bf16 v[14:17], v[78:81], v[46:49], v[14:17]
    ds_read_b128 v[38:41], v252 offset:23552
    s_waitcnt lgkmcnt(4)
    v_add_f32 v50, 1.0, v50
    v_mfma_f32_16x16x32_bf16 v[10:13], v[82:85], v[18:21], v[10:13]
    buffer_load_dwordx4 v1, s[4:7], s36 offen offset:1024 sc1 lds
    v_exp_f32 v52, v52
    v_mfma_f32_16x16x32_bf16 v[14:17], v[86:89], v[18:21], v[14:17]
    ds_read_b128 v[42:45], v252 offset:24576
    v_add_f32 v51, 1.0, v51
    v_mfma_f32_16x16x32_bf16 v[10:13], v[90:93], v[22:25], v[10:13]
    buffer_load_dwordx4 v1, s[4:7], s36 offen offset:2048 sc1 lds
    v_exp_f32 v53, v53
    v_mfma_f32_16x16x32_bf16 v[14:17], v[94:97], v[22:25], v[14:17]
    ds_read_b128 v[46:49], v252 offset:25600
    s_waitcnt lgkmcnt(4)
    v_add_f32 v52, 1.0, v52
    v_mfma_f32_16x16x32_bf16 v[10:13], v[98:101], v[26:29], v[10:13]
    buffer_load_dwordx4 v1, s[4:7], s36 offen offset:3072 sc1 lds
    v_exp_f32 v54, v54
    v_mfma_f32_16x16x32_bf16 v[14:17], v[102:105], v[26:29], v[14:17]
    ds_read_b128 v[18:21], v252 offset:26624
    v_add_f32 v53, 1.0, v53
    v_mfma_f32_16x16x32_bf16 v[10:13], v[106:109], v[30:33], v[10:13]
    buffer_load_dwordx4 a[160:163], v1, s[4:7], s76 offen offset:2048 sc1
    v_exp_f32 v55, v55
    v_mfma_f32_16x16x32_bf16 v[14:17], v[110:113], v[30:33], v[14:17]
    ds_read_b128 v[22:25], v252 offset:27648
    s_waitcnt lgkmcnt(4)
    v_add_f32 v54, 1.0, v54
    v_mfma_f32_16x16x32_bf16 v[10:13], v[114:117], v[34:37], v[10:13]
    buffer_load_dwordx4 a[164:167], v1, s[4:7], s80 offen offset:2048 sc1
    v_exp_f32 v56, v56
    v_mfma_f32_16x16x32_bf16 v[14:17], v[118:121], v[34:37], v[14:17]
    ds_read_b128 v[26:29], v252 offset:28672
    buffer_load_dwordx4 a[168:171], v1, s[4:7], s84 offen offset:2048 sc1
    v_add_f32 v55, 1.0, v55
    v_mfma_f32_16x16x32_bf16 v[10:13], v[122:125], v[38:41], v[10:13]
    s_waitcnt vmcnt(17)
    s_barrier
    v_exp_f32 v57, v57
    v_mfma_f32_16x16x32_bf16 v[14:17], v[126:129], v[38:41], v[14:17]
    ds_read_b128 v[30:33], v252 offset:29696
    s_waitcnt lgkmcnt(4)
    v_add_f32 v56, 1.0, v56
    v_mfma_f32_16x16x32_bf16 v[10:13], v[130:133], v[42:45], v[10:13]
    buffer_load_dwordx4 a[172:175], v1, s[4:7], s88 offen offset:2048 sc1
    v_rcp_f32 v50, v50
    v_mfma_f32_16x16x32_bf16 v[14:17], v[134:137], v[42:45], v[14:17]
    ds_read_b128 v[34:37], v252 offset:32768
    ds_read_b64 v[216:217], v246 offset:768
    v_add_f32 v57, 1.0, v57
    v_mfma_f32_16x16x32_bf16 v[10:13], v[138:141], v[46:49], v[10:13]
    buffer_load_dwordx4 a[176:179], v1, s[4:7], s76 offen offset:3072 sc1
    v_rcp_f32 v51, v51
    v_mfma_f32_16x16x32_bf16 v[14:17], v[142:145], v[46:49], v[14:17]
    ds_read_b128 v[38:41], v252 offset:33792
    s_waitcnt lgkmcnt(4)
    v_mfma_f32_16x16x32_bf16 v[10:13], v[146:149], v[18:21], v[10:13]
    s_waitcnt vmcnt(23)
    s_cmp_eq_u32 s101, 0
    s_cbranch_scc1 L_slow_21
    buffer_store_dword v254, v241, s[4:7], 0 offen offset:256
    s_branch L_st_22
L_slow_21:
    buffer_store_dword v254, v241, s[4:7], 0 offen offset:256 sc1
L_st_22:
    v_rcp_f32 v52, v52
    v_mfma_f32_16x16x32_bf16 v[14:17], v[150:153], v[18:21], v[14:17]
    ds_read_b128 v[42:45], v252 offset:34816
    v_mfma_f32_16x16x32_bf16 v[10:13], v[154:157], v[22:25], v[10:13]
    s_mov_b64 exec, s[30:31]
    buffer_load_dword v244, v243, s[4:7], 0 offen offset:0 sc1
    s_mov_b64 exec, -1
    buffer_load_dwordx4 a[180:183], v1, s[4:7], s80 offen offset:3072 sc1
    v_rcp_f32 v53, v53
    v_mfma_f32_16x16x32_bf16 v[14:17], v[158:161], v[22:25], v[14:17]
    ds_read_b128 v[46:49], v252 offset:35840
    s_waitcnt lgkmcnt(4)
    v_mfma_f32_16x16x32_bf16 v[10:13], v[162:165], v[26:29], v[10:13]
    buffer_load_dwordx4 a[184:187], v1, s[4:7], s84 offen offset:3072 sc1
    v_rcp_f32 v54, v54
    v_mfma_f32_16x16x32_bf16 v[14:17], v[166:169], v[26:29], v[14:17]
    ds_read_b128 v[18:21], v252 offset:36864
    v_rcp_f32 v56, v56
    v_mfma_f32_16x16x32_bf16 v[10:13], v[170:173], v[30:33], v[10:13]
    buffer_load_dwordx4 a[188:191], v1, s[4:7], s88 offen offset:3072 sc1
    v_rcp_f32 v55, v55
    v_mfma_f32_16x16x32_bf16 v[14:17], v[174:177], v[30:33], v[14:17]
    ds_read_b128 v[22:25], v252 offset:37888
    s_waitcnt lgkmcnt(4)
    v_rcp_f32 v57, v57
    v_pk_mul_f32 v[50:51], v[50:51], v[2:3]
    v_pk_mul_f32 v[52:53], v[52:53], v[4:5]
    v_pk_mul_f32 v[54:55], v[54:55], v[6:7]
    v_pk_mul_f32 v[56:57], v[56:57], v[8:9]
    v_cvt_pk_bf16_f32 v58, v50, v51
    v_cvt_pk_bf16_f32 v59, v52, v53
    v_cvt_pk_bf16_f32 v60, v54, v55
    v_cvt_pk_bf16_f32 v61, v56, v57
    s_add_u32 s24, s32, 114688
    buffer_store_dwordx4 v[58:61], v1, s[4:7], s24 offen sc1
    v_pk_fma_f32 v[10:11], v[178:179], v[216:217], v[10:11] op_sel_hi:[1,0,1] neg_lo:[0,1,0] neg_hi:[0,1,0]
    v_pk_fma_f32 v[12:13], v[180:181], v[216:217], v[12:13] op_sel_hi:[1,0,1] neg_lo:[0,1,0] neg_hi:[0,1,0]
    v_pk_fma_f32 v[14:15], v[182:183], v[216:217], v[14:15] op_sel_hi:[1,0,1] neg_lo:[0,1,0] neg_hi:[0,1,0]
    v_pk_fma_f32 v[16:17], v[184:185], v[216:217], v[16:17] op_sel_hi:[1,0,1] neg_lo:[0,1,0] neg_hi:[0,1,0]
    v_pk_fma_f32 v[10:11], v[10:11], v[216:217], v[186:187] op_sel:[0,1,0] op_sel_hi:[1,1,1]
    v_pk_fma_f32 v[12:13], v[12:13], v[216:217], v[188:189] op_sel:[0,1,0] op_sel_hi:[1,1,1]
    v_pk_fma_f32 v[14:15], v[14:15], v[216:217], v[190:191] op_sel:[0,1,0] op_sel_hi:[1,1,1]
    v_pk_fma_f32 v[16:17], v[16:17], v[216:217], v[192:193] op_sel:[0,1,0] op_sel_hi:[1,1,1]
    v_pk_mul_f32 v[50:51], v[10:11], v[10:11]
    v_pk_mul_f32 v[52:53], v[12:13], v[12:13]
    v_pk_mul_f32 v[54:55], v[14:15], v[14:15]
    v_pk_mul_f32 v[56:57], v[16:17], v[16:17]
    v_pk_fma_f32 v[50:51], v[50:51], s[34:35], v[218:219]
    v_pk_fma_f32 v[52:53], v[52:53], s[34:35], v[218:219]
    v_pk_fma_f32 v[54:55], v[54:55], s[34:35], v[218:219]
    v_pk_fma_f32 v[56:57], v[56:57], s[34:35], v[218:219]
    v_pk_mul_f32 v[50:51], v[50:51], v[10:11]
    v_pk_mul_f32 v[52:53], v[52:53], v[12:13]
    v_pk_mul_f32 v[54:55], v[54:55], v[14:15]
    v_pk_mul_f32 v[56:57], v[56:57], v[16:17]
    v_mfma_f32_16x16x32_bf16 v[2:5], v[66:69], v[34:37], 0
    v_exp_f32 v50, v50
    v_mfma_f32_16x16x32_bf16 v[6:9], v[70:73], v[34:37], 0
    ds_read_b128 v[26:29], v252 offset:38912
    v_mfma_f32_16x16x32_bf16 v[2:5], v[74:77], v[38:41], v[2:5]
    s_waitcnt vmcnt(4)
    s_mov_b64 exec, s[30:31]
    v_cmp_ne_u32 vcc, s47, v244
    s_mov_b64 exec, -1
    s_nop 2
    s_cbranch_vccz L_early_23
    s_mov_b64 s[94:95], s[30:31]
    s_mov_b64 exec, s[94:95]
    s_mov_b32 s49, 0
L_poll_24:
    buffer_load_dword v253, v243, s[4:7], 0 offen sc1
    s_waitcnt vmcnt(0)
    v_cmp_ne_u32 vcc, s47, v253
    s_nop 4
    s_cbranch_vccz L_polldone_25
    s_add_u32 s49, s49, 1
    s_cmp_lt_u32 s49, 200000
    s_cbranch_scc1 L_poll_24
    s_add_u32 s99, s99, 1
L_polldone_25:
    s_mov_b64 exec, -1
L_early_23:
    v_exp_f32 v51, v51
    v_mfma_f32_16x16x32_bf16 v[6:9], v[78:81], v[38:41], v[6:9]
    ds_read_b128 v[30:33], v252 offset:39936
    s_waitcnt lgkmcnt(4)
    v_add_f32 v50, 1.0, v50
    v_mfma_f32_16x16x32_bf16 v[2:5], v[82:85], v[42:45], v[2:5]
    buffer_load_dwordx4 v[194:197], v1, s[4:7], s25 offen offset:0 sc1
    v_exp_f32 v52, v52
    v_mfma_f32_16x16x32_bf16 v[6:9], v[86:89], v[42:45], v[6:9]
    ds_read_b128 v[34:37], v252 offset:40960
    v_add_f32 v51, 1.0, v51
    v_mfma_f32_16x16x32_bf16 v[2:5], v[90:93], v[46:49], v[2:5]
    buffer_load_dwordx4 v[198:201], v1, s[4:7], s25 offen offset:1024 sc1
    v_exp_f32 v53, v53
    v_mfma_f32_16x16x32_bf16 v[6:9], v[94:97], v[46:49], v[6:9]
    ds_read_b128 v[38:41], v252 offset:41984
    s_waitcnt lgkmcnt(4)
    v_add_f32 v52, 1.0, v52
    v_mfma_f32_16x16x32_bf16 v[2:5], v[98:101], v[18:21], v[2:5]
    buffer_load_dwordx4 v[202:205], v1, s[4:7], s25 offen offset:2048 sc1
    v_exp_f32 v54, v54
    v_mfma_f32_16x16x32_bf16 v[6:9], v[102:105], v[18:21], v[6:9]
    ds_read_b128 v[42:45], v252 offset:43008
    v_add_f32 v53, 1.0, v53
    v_mfma_f32_16x16x32_bf16 v[2:5], v[106:109], v[22:25], v[2:5]
    buffer_load_dwordx4 a[192:195], v1, s[4:7], s77 offen offset:0 sc1
    v_exp_f32 v55, v55
    v_mfma_f32_16x16x32_bf16 v[6:9], v[110:113], v[22:25], v[6:9]
    ds_read_b128 v[46:49], v252 offset:44032
    s_waitcnt lgkmcnt(4)
    v_add_f32 v54, 1.0, v54
    v_mfma_f32_16x16x32_bf16 v[2:5], v[114:117], v[26:29], v[2:5]
    buffer_load_dwordx4 a[196:199], v1, s[4:7], s81 offen offset:0 sc1
    v_exp_f32 v56, v56
    v_mfma_f32_16x16x32_bf16 v[6:9], v[118:121], v[26:29], v[6:9]
    ds_read_b128 v[18:21], v252 offset:45056
    buffer_load_dwordx4 a[200:203], v1, s[4:7], s85 offen offset:0 sc1
    v_add_f32 v55, 1.0, v55
    v_mfma_f32_16x16x32_bf16 v[2:5], v[122:125], v[30:33], v[2:5]
    s_waitcnt vmcnt(17)
    s_barrier
    v_exp_f32 v57, v57
    v_mfma_f32_16x16x32_bf16 v[6:9], v[126:129], v[30:33], v[6:9]
    ds_read_b128 v[22:25], v252 offset:46080
    s_waitcnt lgkmcnt(4)
    v_add_f32 v56, 1.0, v56
    v_mfma_f32_16x16x32_bf16 v[2:5], v[130:133], v[34:37], v[2:5]
    buffer_load_dwordx4 a[204:207], v1, s[4:7], s89 offen offset:0 sc1
    v_rcp_f32 v50, v50
    v_mfma_f32_16x16x32_bf16 v[6:9], v[134:137], v[34:37], v[6:9]
    ds_read_b128 v[26:29], v252 offset:49152
    ds_read_b64 v[214:215], v246 offset:384
    v_add_f32 v57, 1.0, v57
    v_mfma_f32_16x16x32_bf16 v[2:5], v[138:141], v[38:41], v[2:5]
    buffer_load_dwordx4 a[208:211], v1, s[4:7], s77 offen offset:1024 sc1
    v_rcp_f32 v51, v51
    v_mfma_f32_16x16x32_bf16 v[6:9], v[142:145], v[38:41], v[6:9]
    ds_read_b128 v[30:33], v252 offset:50176
    s_waitcnt lgkmcnt(4)
    v_mfma_f32_16x16x32_bf16 v[2:5], v[146:149], v[42:45], v[2:5]
    s_waitcnt vmcnt(23)
    s_cmp_eq_u32 s101, 0
    s_cbranch_scc1 L_slow_26
    buffer_store_dword v254, v241, s[4:7], 0 offen offset:1280
    s_branch L_st_27
L_slow_26:
    buffer_store_dword v254, v241, s[4:7], 0 offen offset:1280 sc1
L_st_27:
    buffer_load_dwordx4 v[206:209], v1, s[4:7], s25 offen offset:3072 sc1
    v_rcp_f32 v52, v52
    v_mfma_f32_16x16x32_bf16 v[6:9], v[150:153], v[42:45], v[6:9]
    ds_read_b128 v[34:37], v252 offset:51200
    v_mfma_f32_16x16x32_bf16 v[2:5], v[154:157], v[46:49], v[2:5]
    buffer_load_dwordx4 v[210:213], v1, s[4:7], s27 offen offset:0 sc1
    buffer_load_dwordx4 a[212:215], v1, s[4:7], s81 offen offset:1024 sc1
    v_rcp_f32 v53, v53
    v_mfma_f32_16x16x32_bf16 v[6:9], v[158:161], v[46:49], v[6:9]
    ds_read_b128 v[38:41], v252 offset:52224
    s_waitcnt lgkmcnt(4)
    v_mfma_f32_16x16x32_bf16 v[2:5], v[162:165], v[18:21], v[2:5]
    buffer_load_dwordx4 a[216:219], v1, s[4:7], s85 offen offset:1024 sc1
    v_rcp_f32 v54, v54
    v_mfma_f32_16x16x32_bf16 v[6:9], v[166:169], v[18:21], v[6:9]
    ds_read_b128 v[42:45], v252 offset:53248
    v_rcp_f32 v56, v56
    v_mfma_f32_16x16x32_bf16 v[2:5], v[170:173], v[22:25], v[2:5]
    buffer_load_dwordx4 a[220:223], v1, s[4:7], s89 offen offset:1024 sc1
    v_rcp_f32 v55, v55
    v_mfma_f32_16x16x32_bf16 v[6:9], v[174:177], v[22:25], v[6:9]
    ds_read_b128 v[46:49], v252 offset:54272
    s_waitcnt lgkmcnt(4)
    v_rcp_f32 v57, v57
    v_pk_mul_f32 v[50:51], v[50:51], v[10:11]
    v_pk_mul_f32 v[52:53], v[52:53], v[12:13]
    v_pk_mul_f32 v[54:55], v[54:55], v[14:15]
    v_pk_mul_f32 v[56:57], v[56:57], v[16:17]
    v_cvt_pk_bf16_f32 v62, v50, v51
    v_cvt_pk_bf16_f32 v63, v52, v53
    v_cvt_pk_bf16_f32 v64, v54, v55
    v_cvt_pk_bf16_f32 v65, v56, v57
    s_add_u32 s24, s32, 344064
    buffer_store_dwordx4 v[62:65], v1, s[4:7], s24 offen sc1
    v_pk_fma_f32 v[2:3], v[178:179], v[214:215], v[2:3] op_sel_hi:[1,0,1] neg_lo:[0,1,0] neg_hi:[0,1,0]
    v_pk_fma_f32 v[4:5], v[180:181], v[214:215], v[4:5] op_sel_hi:[1,0,1] neg_lo:[0,1,0] neg_hi:[0,1,0]
    v_pk_fma_f32 v[6:7], v[182:183], v[214:215], v[6:7] op_sel_hi:[1,0,1] neg_lo:[0,1,0] neg_hi:[0,1,0]
    v_pk_fma_f32 v[8:9], v[184:185], v[214:215], v[8:9] op_sel_hi:[1,0,1] neg_lo:[0,1,0] neg_hi:[0,1,0]
    v_pk_fma_f32 v[2:3], v[2:3], v[214:215], v[186:187] op_sel:[0,1,0] op_sel_hi:[1,1,1]
    v_pk_fma_f32 v[4:5], v[4:5], v[214:215], v[188:189] op_sel:[0,1,0] op_sel_hi:[1,1,1]
    v_pk_fma_f32 v[6:7], v[6:7], v[214:215], v[190:191] op_sel:[0,1,0] op_sel_hi:[1,1,1]
    v_pk_fma_f32 v[8:9], v[8:9], v[214:215], v[192:193] op_sel:[0,1,0] op_sel_hi:[1,1,1]
    v_pk_mul_f32 v[50:51], v[2:3], v[2:3]
    v_pk_mul_f32 v[52:53], v[4:5], v[4:5]
    v_pk_mul_f32 v[54:55], v[6:7], v[6:7]
    v_pk_mul_f32 v[56:57], v[8:9], v[8:9]
    v_pk_fma_f32 v[50:51], v[50:51], s[34:35], v[218:219]
    v_pk_fma_f32 v[52:53], v[52:53], s[34:35], v[218:219]
    v_pk_fma_f32 v[54:55], v[54:55], s[34:35], v[218:219]
    v_pk_fma_f32 v[56:57], v[56:57], s[34:35], v[218:219]
    v_pk_mul_f32 v[50:51], v[50:51], v[2:3]
    v_pk_mul_f32 v[52:53], v[52:53], v[4:5]
    v_pk_mul_f32 v[54:55], v[54:55], v[6:7]
    v_pk_mul_f32 v[56:57], v[56:57], v[8:9]
    v_mfma_f32_16x16x32_bf16 v[10:13], v[66:69], v[26:29], 0
    v_exp_f32 v50, v50
    v_mfma_f32_16x16x32_bf16 v[14:17], v[70:73], v[26:29], 0
    ds_read_b128 v[18:21], v252 offset:55296
    v_mfma_f32_16x16x32_bf16 v[10:13], v[74:77], v[30:33], v[10:13]
    buffer_load_dwordx4 v[220:223], v1, s[4:7], s27 offen offset:1024 sc1
    v_exp_f32 v51, v51
    v_mfma_f32_16x16x32_bf16 v[14:17], v[78:81], v[30:33], v[14:17]
    ds_read_b128 v[22:25], v252 offset:56320
    s_waitcnt lgkmcnt(4)
    v_add_f32 v50, 1.0, v50
    v_mfma_f32_16x16x32_bf16 v[10:13], v[82:85], v[34:37], v[10:13]
    buffer_load_dwordx4 v[224:227], v1, s[4:7], s27 offen offset:2048 sc1
    v_exp_f32 v52, v52
    v_mfma_f32_16x16x32_bf16 v[14:17], v[86:89], v[34:37], v[14:17]
    ds_read_b128 v[26:29], v252 offset:57344
    v_add_f32 v51, 1.0, v51
    v_mfma_f32_16x16x32_bf16 v[10:13], v[90:93], v[38:41], v[10:13]
    buffer_load_dwordx4 v[228:231], v1, s[4:7], s27 offen offset:3072 sc1
    v_exp_f32 v53, v53
    v_mfma_f32_16x16x32_bf16 v[14:17], v[94:97], v[38:41], v[14:17]
    ds_read_b128 v[30:33], v252 offset:58368
    s_waitcnt lgkmcnt(4)
    v_add_f32 v52, 1.0, v52
    v_mfma_f32_16x16x32_bf16 v[10:13], v[98:101], v[42:45], v[10:13]
    buffer_load_dwordx4 v[232:235], v1, s[4:7], s29 offen offset:0 sc1
    v_exp_f32 v54, v54
    v_mfma_f32_16x16x32_bf16 v[14:17], v[102:105], v[42:45], v[14:17]
    ds_read_b128 v[34:37], v252 offset:59392
    v_add_f32 v53, 1.0, v53
    v_mfma_f32_16x16x32_bf16 v[10:13], v[106:109], v[46:49], v[10:13]
    v_exp_f32 v55, v55
    v_mfma_f32_16x16x32_bf16 v[14:17], v[110:113], v[46:49], v[14:17]
    ds_read_b128 v[38:41], v252 offset:60416
    s_waitcnt lgkmcnt(4)
    v_add_f32 v54, 1.0, v54
    v_mfma_f32_16x16x32_bf16 v[10:13], v[114:117], v[18:21], v[10:13]
    v_exp_f32 v56, v56
    v_mfma_f32_16x16x32_bf16 v[14:17], v[118:121], v[18:21], v[14:17]
    ds_read_b128 v[42:45], v252 offset:61440
    v_add_f32 v55, 1.0, v55
    v_mfma_f32_16x16x32_bf16 v[10:13], v[122:125], v[22:25], v[10:13]
    v_exp_f32 v57, v57
    v_mfma_f32_16x16x32_bf16 v[14:17], v[126:129], v[22:25], v[14:17]
    ds_read_b128 v[46:49], v252 offset:62464
    s_waitcnt lgkmcnt(4)
    v_add_f32 v56, 1.0, v56
    v_mfma_f32_16x16x32_bf16 v[10:13], v[130:133], v[26:29], v[10:13]
    v_rcp_f32 v50, v50
    v_mfma_f32_16x16x32_bf16 v[14:17], v[134:137], v[26:29], v[14:17]
    ds_read_b64 v[216:217], v246 offset:896
    v_add_f32 v57, 1.0, v57
    v_mfma_f32_16x16x32_bf16 v[10:13], v[138:141], v[30:33], v[10:13]
    v_rcp_f32 v51, v51
    v_mfma_f32_16x16x32_bf16 v[14:17], v[142:145], v[30:33], v[14:17]
    s_waitcnt lgkmcnt(2)
    v_mfma_f32_16x16x32_bf16 v[10:13], v[146:149], v[34:37], v[10:13]
    s_waitcnt vmcnt(19)
    s_cmp_eq_u32 s101, 0
    s_cbranch_scc1 L_slow_28
    buffer_store_dword v254, v241, s[4:7], 0 offen offset:512
    s_branch L_st_29
L_slow_28:
    buffer_store_dword v254, v241, s[4:7], 0 offen offset:512 sc1
L_st_29:
    v_rcp_f32 v52, v52
    v_mfma_f32_16x16x32_bf16 v[14:17], v[150:153], v[34:37], v[14:17]
    v_mfma_f32_16x16x32_bf16 v[10:13], v[154:157], v[38:41], v[10:13]
    v_rcp_f32 v53, v53
    v_mfma_f32_16x16x32_bf16 v[14:17], v[158:161], v[38:41], v[14:17]
    s_waitcnt lgkmcnt(0)
    v_mfma_f32_16x16x32_bf16 v[10:13], v[162:165], v[42:45], v[10:13]
    v_rcp_f32 v54, v54
    v_mfma_f32_16x16x32_bf16 v[14:17], v[166:169], v[42:45], v[14:17]
    v_rcp_f32 v56, v56
    v_mfma_f32_16x16x32_bf16 v[10:13], v[170:173], v[46:49], v[10:13]
    v_rcp_f32 v55, v55
    v_mfma_f32_16x16x32_bf16 v[14:17], v[174:177], v[46:49], v[14:17]
    v_rcp_f32 v57, v57
L_c_done:
    s_lshl_b32 s90, s46, 13
    s_add_u32 s90, s90, 86016
    v_add_u32 v248, s90, v1
    s_and_b32 s90, s46, 1
    s_lshl_b32 s90, s90, 11
    s_lshr_b32 s91, s46, 1
    s_lshl_b32 s91, s91, 12
    s_add_u32 s90, s90, s91
    s_add_u32 s90, s90, 86016
    v_add_u32 v249, s90, v1
    s_lshr_b32 s91, s46, 1
    s_lshl_b32 s92, s44, 2
    s_add_u32 s91, s91, s92
    s_and_b32 s90, s46, 1
    s_lshl_b32 s92, s45, 1
    s_add_u32 s90, s90, s92
    s_mul_i32 s92, s91, 14
    s_add_u32 s92, s92, s90
    s_lshl_b32 s36, s92, 10
    s_lshl_b32 s37, s92, 7
    s_lshl_b32 s28, s91, 5
    s_add_u32 s28, s28, s90
    s_lshl_b32 s28, s28, 2
    s_add_u32 s36, s36, 7081984
    s_add_u32 s37, s37, 9146368
    s_add_u32 s28, s28, 28672
    s_add_u32 s33, s36, 28672
    s_and_b32 s90, s44, 1
    s_lshr_b32 s91, s46, 1
    s_and_b32 s90, s90, s91
    s_xor_b32 s90, s90, 1
    s_and_b32 s29, s27, s90
    s_mov_b32 s26, s101
    s_cmp_eq_u32 s90, 0
    s_cselect_b32 s92, 0, 0x80000000
    s_add_u32 s90, s42, 1
    s_lshl_b32 s90, s90, 5
    s_lshl_b32 s91, s45, 1
    s_add_u32 s90, s90, s91
    s_and_b32 s91, s46, 1
    s_add_u32 s90, s90, s91
    s_lshl_b32 s90, s90, 2
    s_add_u32 s90, s90, 176128
    s_or_b32 s20, s90, s92
    s_mul_i32 s90, s48, 7340032
    s_add_u32 s90, s90, 17698816
    s_mul_i32 s91, s44, 229376
    s_add_u32 s90, s90, s91
    s_mul_i32 s91, s46, 14336
    s_add_u32 s74, s90, s91
    s_add_u32 s75, s74, 4096
    s_add_u32 s76, s74, 8192
    s_add_u32 s77, s74, 12288
    s_add_u32 s78, s74, 57344
    s_add_u32 s79, s78, 4096
    s_add_u32 s80, s78, 8192
    s_add_u32 s81, s78, 12288
    s_add_u32 s82, s78, 57344
    s_add_u32 s83, s82, 4096
    s_add_u32 s84, s82, 8192
    s_add_u32 s85, s82, 12288
    s_add_u32 s86, s82, 57344
    s_add_u32 s87, s86, 4096
    s_add_u32 s88, s86, 8192
    s_add_u32 s89, s86, 12288
    s_cmp_eq_u32 s48, 0
    s_cbranch_scc1 L_d_nout
    s_lshr_b32 s91, s46, 1
    s_lshl_b32 s92, s44, 2
    s_add_u32 s91, s91, s92
    s_and_b32 s90, s46, 1
    s_lshl_b32 s92, s45, 1
    s_add_u32 s90, s90, s92
    s_mul_i32 s36, s91, 14336
    s_lshl_b32 s90, s90, 6
    s_add_u32 s36, s36, s90
    s_add_u32 s33, s36, 28672
L_d_nout:
    v_and_b32 v250, 15, v0
    v_lshrrev_b32 v251, 4, v0
    v_mul_u32_u24 v242, 896, v250
    v_and_b32 v253, 1, v251
    v_lshl_add_u32 v242, v253, 5, v242
    v_lshrrev_b32 v253, 1, v251
    v_lshl_add_u32 v242, v253, 4, v242
    buffer_load_dwordx4 v[102:105], v1, s[4:7], s76 offen offset:1024 sc1
    s_mov_b64 exec, s[30:31]
    buffer_load_dword v244, v243, s[4:7], 0 offen offset:256 sc1
    s_mov_b64 exec, -1
    v_pk_mul_f32 v[50:51], v[50:51], v[2:3]
    v_pk_mul_f32 v[52:53], v[52:53], v[4:5]
    v_pk_mul_f32 v[54:55], v[54:55], v[6:7]
    v_pk_mul_f32 v[56:57], v[56:57], v[8:9]
    v_cvt_pk_bf16_f32 v58, v50, v51
    v_cvt_pk_bf16_f32 v59, v52, v53
    v_cvt_pk_bf16_f32 v60, v54, v55
    v_cvt_pk_bf16_f32 v61, v56, v57
    s_add_u32 s24, s32, 172032
    buffer_store_dwordx4 v[58:61], v1, s[4:7], s24 offen sc1
    s_waitcnt lgkmcnt(0)
    v_pk_fma_f32 v[10:11], v[178:179], v[216:217], v[10:11] op_sel_hi:[1,0,1] neg_lo:[0,1,0] neg_hi:[0,1,0]
    v_pk_fma_f32 v[12:13], v[180:181], v[216:217], v[12:13] op_sel_hi:[1,0,1] neg_lo:[0,1,0] neg_hi:[0,1,0]
    v_pk_fma_f32 v[14:15], v[182:183], v[216:217], v[14:15] op_sel_hi:[1,0,1] neg_lo:[0,1,0] neg_hi:[0,1,0]
    v_pk_fma_f32 v[16:17], v[184:185], v[216:217], v[16:17] op_sel_hi:[1,0,1] neg_lo:[0,1,0] neg_hi:[0,1,0]
    v_pk_fma_f32 v[10:11], v[10:11], v[216:217], v[186:187] op_sel:[0,1,0] op_sel_hi:[1,1,1]
    v_pk_fma_f32 v[12:13], v[12:13], v[216:217], v[188:189] op_sel:[0,1,0] op_sel_hi:[1,1,1]
    v_pk_fma_f32 v[14:15], v[14:15], v[216:217], v[190:191] op_sel:[0,1,0] op_sel_hi:[1,1,1]
    v_pk_fma_f32 v[16:17], v[16:17], v[216:217], v[192:193] op_sel:[0,1,0] op_sel_hi:[1,1,1]
    v_pk_mul_f32 v[50:51], v[10:11], v[10:11]
    v_pk_mul_f32 v[52:53], v[12:13], v[12:13]
    v_pk_mul_f32 v[54:55], v[14:15], v[14:15]
    v_pk_mul_f32 v[56:57], v[16:17], v[16:17]
    v_pk_fma_f32 v[50:51], v[50:51], s[34:35], v[218:219]
    v_pk_fma_f32 v[52:53], v[52:53], s[34:35], v[218:219]
    v_pk_fma_f32 v[54:55], v[54:55], s[34:35], v[218:219]
    v_pk_fma_f32 v[56:57], v[56:57], s[34:35], v[218:219]
    v_pk_mul_f32 v[50:51], v[50:51], v[10:11]
    v_pk_mul_f32 v[52:53], v[52:53], v[12:13]
    v_pk_mul_f32 v[54:55], v[54:55], v[14:15]
    v_pk_mul_f32 v[56:57], v[56:57], v[16:17]
    v_exp_f32 v50, v50
    v_exp_f32 v51, v51
    v_exp_f32 v52, v52
    v_exp_f32 v53, v53
    v_exp_f32 v54, v54
    v_exp_f32 v55, v55
    v_exp_f32 v56, v56
    v_exp_f32 v57, v57
    v_pk_add_f32 v[50:51], v[50:51], 1.0 op_sel_hi:[1,0]
    v_pk_add_f32 v[52:53], v[52:53], 1.0 op_sel_hi:[1,0]
    v_pk_add_f32 v[54:55], v[54:55], 1.0 op_sel_hi:[1,0]
    v_pk_add_f32 v[56:57], v[56:57], 1.0 op_sel_hi:[1,0]
    v_rcp_f32 v50, v50
    v_rcp_f32 v51, v51
    v_rcp_f32 v52, v52
    v_rcp_f32 v53, v53
    v_rcp_f32 v54, v54
    v_rcp_f32 v55, v55
    v_rcp_f32 v56, v56
    v_rcp_f32 v57, v57
    v_pk_mul_f32 v[50:51], v[50:51], v[10:11]
    v_pk_mul_f32 v[52:53], v[52:53], v[12:13]
    v_pk_mul_f32 v[54:55], v[54:55], v[14:15]
    v_pk_mul_f32 v[56:57], v[56:57], v[16:17]
    v_cvt_pk_bf16_f32 v62, v50, v51
    v_cvt_pk_bf16_f32 v63, v52, v53
    v_cvt_pk_bf16_f32 v64, v54, v55
    v_cvt_pk_bf16_f32 v65, v56, v57
    s_waitcnt vmcnt(8)
    s_cmp_eq_u32 s101, 0
    s_cbranch_scc1 L_slow_43
    buffer_store_dword v254, v241, s[4:7], 0 offen offset:1536
    s_branch L_st_44
L_slow_43:
    buffer_store_dword v254, v241, s[4:7], 0 offen offset:1536 sc1
L_st_44:
    s_add_u32 s24, s32, 401408
    buffer_store_dwordx4 v[62:65], v1, s[4:7], s24 offen sc1
    s_barrier
    s_waitcnt vmcnt(16)
    v_mfma_f32_16x16x32_bf16 v[130:133], a[0:3], v[194:197], 0
    buffer_load_dwordx4 v[106:109], v1, s[4:7], s76 offen offset:2048 sc1
    v_mfma_f32_16x16x32_bf16 v[134:137], a[4:7], v[194:197], 0
    v_mfma_f32_16x16x32_bf16 v[138:141], a[8:11], v[194:197], 0
    v_mfma_f32_16x16x32_bf16 v[142:145], a[12:15], v[194:197], 0
    s_waitcnt vmcnt(16)
    v_mfma_f32_16x16x32_bf16 v[130:133], a[16:19], v[198:201], v[130:133]
    buffer_load_dwordx4 v[110:113], v1, s[4:7], s76 offen offset:3072 sc1
    v_mfma_f32_16x16x32_bf16 v[134:137], a[20:23], v[198:201], v[134:137]
    v_mfma_f32_16x16x32_bf16 v[138:141], a[24:27], v[198:201], v[138:141]
    v_mfma_f32_16x16x32_bf16 v[142:145], a[28:31], v[198:201], v[142:145]
    s_waitcnt vmcnt(16)
    v_mfma_f32_16x16x32_bf16 v[130:133], a[32:35], v[202:205], v[130:133]
    buffer_load_dwordx4 v[114:117], v1, s[4:7], s77 offen offset:0 sc1
    v_mfma_f32_16x16x32_bf16 v[134:137], a[36:39], v[202:205], v[134:137]
    v_mfma_f32_16x16x32_bf16 v[138:141], a[40:43], v[202:205], v[138:141]
    v_mfma_f32_16x16x32_bf16 v[142:145], a[44:47], v[202:205], v[142:145]
    s_waitcnt vmcnt(15)
    v_mfma_f32_16x16x32_bf16 v[130:133], a[48:51], v[206:209], v[130:133]
    buffer_load_dwordx4 v[118:121], v1, s[4:7], s77 offen offset:1024 sc1
    v_mfma_f32_16x16x32_bf16 v[134:137], a[52:55], v[206:209], v[134:137]
    v_mfma_f32_16x16x32_bf16 v[138:141], a[56:59], v[206:209], v[138:141]
    v_mfma_f32_16x16x32_bf16 v[142:145], a[60:63], v[206:209], v[142:145]
    s_waitcnt vmcnt(15)
    v_mfma_f32_16x16x32_bf16 v[130:133], a[64:67], v[210:213], v[130:133]
    s_waitcnt vmcnt(7)
    s_mov_b64 exec, s[30:31]
    v_cmp_ne_u32 vcc, s47, v244
    s_mov_b64 exec, -1
    s_nop 2
    s_cbranch_vccz L_early_45
    s_mov_b64 s[94:95], s[30:31]
    v_add_u32 v253, 256, v243
    v_mov_b32 v244, v253
    s_mov_b64 exec, s[94:95]
    s_mov_b32 s49, 0
L_poll_46:
    buffer_load_dword v253, v244, s[4:7], 0 offen sc1
    s_waitcnt vmcnt(0)
    v_cmp_ne_u32 vcc, s47, v253
    s_nop 4
    s_cbranch_vccz L_polldone_47
    s_add_u32 s49, s49, 1
    s_cmp_lt_u32 s49, 200000
    s_cbranch_scc1 L_poll_46
    s_add_u32 s99, s99, 1
L_polldone_47:
    s_mov_b64 exec, -1
L_early_45:
    buffer_load_dwordx4 v[122:125], v1, s[4:7], s78 offen offset:0 sc1
    v_mfma_f32_16x16x32_bf16 v[134:137], a[68:71], v[210:213], v[134:137]
    v_mfma_f32_16x16x32_bf16 v[138:141], a[72:75], v[210:213], v[138:141]
    v_mfma_f32_16x16x32_bf16 v[142:145], a[76:79], v[210:213], v[142:145]
    s_waitcnt vmcnt(14)
    v_mfma_f32_16x16x32_bf16 v[130:133], a[80:83], v[220:223], v[130:133]
    buffer_load_dwordx4 v[126:129], v1, s[4:7], s78 offen offset:1024 sc1
    v_mfma_f32_16x16x32_bf16 v[134:137], a[84:87], v[220:223], v[134:137]
    v_mfma_f32_16x16x32_bf16 v[138:141], a[88:91], v[220:223], v[138:141]
    v_mfma_f32_16x16x32_bf16 v[142:145], a[92:95], v[220:223], v[142:145]
    s_waitcnt vmcnt(14)
    s_waitcnt vmcnt(8)
    s_cmp_eq_u32 s101, 0
    s_cbranch_scc1 L_slow_48
    buffer_store_dword v254, v241, s[4:7], 0 offen offset:768
    s_branch L_st_49
L_slow_48:
    buffer_store_dword v254, v241, s[4:7], 0 offen offset:768 sc1
L_st_49:
    v_mfma_f32_16x16x32_bf16 v[130:133], a[96:99], v[224:227], v[130:133]
    buffer_load_dwordx4 v[66:69], v1, s[4:7], s78 offen offset:2048 sc1
    v_mfma_f32_16x16x32_bf16 v[134:137], a[100:103], v[224:227], v[134:137]
    v_mfma_f32_16x16x32_bf16 v[138:141], a[104:107], v[224:227], v[138:141]
    v_mfma_f32_16x16x32_bf16 v[142:145], a[108:111], v[224:227], v[142:145]
    s_waitcnt vmcnt(15)
    v_mfma_f32_16x16x32_bf16 v[130:133], a[112:115], v[228:231], v[130:133]
    buffer_load_dwordx4 v[70:73], v1, s[4:7], s78 offen offset:3072 sc1
    v_mfma_f32_16x16x32_bf16 v[134:137], a[116:119], v[228:231], v[134:137]
    v_mfma_f32_16x16x32_bf16 v[138:141], a[120:123], v[228:231], v[138:141]
    v_mfma_f32_16x16x32_bf16 v[142:145], a[124:127], v[228:231], v[142:145]
    s_waitcnt vmcnt(15)
    v_mfma_f32_16x16x32_bf16 v[130:133], a[128:131], v[232:235], v[130:133]
    buffer_load_dwordx4 v[74:77], v1, s[4:7], s79 offen offset:0 sc1
    v_mfma_f32_16x16x32_bf16 v[134:137], a[132:135], v[232:235], v[134:137]
    v_mfma_f32_16x16x32_bf16 v[138:141], a[136:139], v[232:235], v[138:141]
    v_mfma_f32_16x16x32_bf16 v[142:145], a[140:143], v[232:235], v[142:145]
    s_waitcnt vmcnt(14)
    v_mfma_f32_16x16x32_bf16 v[130:133], a[144:147], v[102:105], v[130:133]
    buffer_load_dwordx4 v[78:81], v1, s[4:7], s79 offen offset:1024 sc1
    v_mfma_f32_16x16x32_bf16 v[134:137], a[148:151], v[102:105], v[134:137]
    v_mfma_f32_16x16x32_bf16 v[138:141], a[152:155], v[102:105], v[138:141]
    v_mfma_f32_16x16x32_bf16 v[142:145], a[156:159], v[102:105], v[142:145]
    s_waitcnt vmcnt(10)
    v_mfma_f32_16x16x32_bf16 v[130:133], a[160:163], v[106:109], v[130:133]
    buffer_load_dwordx4 v[82:85], v1, s[4:7], s79 offen offset:2048 sc1
    s_mov_b64 exec, s[30:31]
    buffer_load_dword v244, v243, s[4:7], 0 offen offset:512 sc1
    s_mov_b64 exec, -1
    v_mfma_f32_16x16x32_bf16 v[134:137], a[164:167], v[106:109], v[134:137]
    v_mfma_f32_16x16x32_bf16 v[138:141], a[168:171], v[106:109], v[138:141]
    v_mfma_f32_16x16x32_bf16 v[142:145], a[172:175], v[106:109], v[142:145]
    s_waitcnt vmcnt(11)
    v_mfma_f32_16x16x32_bf16 v[130:133], a[176:179], v[110:113], v[130:133]
    buffer_load_dwordx4 v[86:89], v1, s[4:7], s79 offen offset:3072 sc1
    v_mfma_f32_16x16x32_bf16 v[134:137], a[180:183], v[110:113], v[134:137]
    v_mfma_f32_16x16x32_bf16 v[138:141], a[184:187], v[110:113], v[138:141]
    v_mfma_f32_16x16x32_bf16 v[142:145], a[188:191], v[110:113], v[142:145]
    s_waitcnt vmcnt(11)
    s_waitcnt vmcnt(14)
    s_cmp_eq_u32 s101, 0
    s_cbranch_scc1 L_slow_50
    buffer_store_dword v254, v241, s[4:7], 0 offen offset:1792
    s_branch L_st_51
L_slow_50:
    buffer_store_dword v254, v241, s[4:7], 0 offen offset:1792 sc1
L_st_51:
    v_mfma_f32_16x16x32_bf16 v[130:133], a[192:195], v[114:117], v[130:133]
    buffer_load_dwordx4 v[90:93], v1, s[4:7], s80 offen offset:0 sc1
    v_mfma_f32_16x16x32_bf16 v[134:137], a[196:199], v[114:117], v[134:137]
    v_mfma_f32_16x16x32_bf16 v[138:141], a[200:203], v[114:117], v[138:141]
    v_mfma_f32_16x16x32_bf16 v[142:145], a[204:207], v[114:117], v[142:145]
    s_waitcnt vmcnt(12)
    v_mfma_f32_16x16x32_bf16 v[130:133], a[208:211], v[118:121], v[130:133]
    buffer_load_dwordx4 v[94:97], v1, s[4:7], s80 offen offset:1024 sc1
    v_mfma_f32_16x16x32_bf16 v[134:137], a[212:215], v[118:121], v[134:137]
    v_mfma_f32_16x16x32_bf16 v[138:141], a[216:219], v[118:121], v[138:141]
    v_mfma_f32_16x16x32_bf16 v[142:145], a[220:223], v[118:121], v[142:145]
    s_waitcnt vmcnt(12)
    v_mfma_f32_16x16x32_bf16 v[146:149], a[0:3], v[122:125], 0
    buffer_load_dwordx4 v[98:101], v1, s[4:7], s80 offen offset:2048 sc1
    v_mfma_f32_16x16x32_bf16 v[150:153], a[4:7], v[122:125], 0
    v_mfma_f32_16x16x32_bf16 v[154:157], a[8:11], v[122:125], 0
    v_mfma_f32_16x16x32_bf16 v[158:161], a[12:15], v[122:125], 0
    ds_write_b128 v248, v[130:133] offset:0
    s_waitcnt vmcnt(12)
    v_mfma_f32_16x16x32_bf16 v[146:149], a[16:19], v[126:129], v[146:149]
    buffer_load_dwordx4 v[102:105], v1, s[4:7], s80 offen offset:3072 sc1
    v_mfma_f32_16x16x32_bf16 v[150:153], a[20:23], v[126:129], v[150:153]
    ds_write_b128 v248, v[134:137] offset:1024
    v_mfma_f32_16x16x32_bf16 v[154:157], a[24:27], v[126:129], v[154:157]
    ds_write_b128 v248, v[138:141] offset:2048
    v_mfma_f32_16x16x32_bf16 v[158:161], a[28:31], v[126:129], v[158:161]
    ds_write_b128 v248, v[142:145] offset:3072
    s_waitcnt vmcnt(11)
    v_mfma_f32_16x16x32_bf16 v[146:149], a[32:35], v[66:69], v[146:149]
    buffer_load_dwordx4 v[106:109], v1, s[4:7], s81 offen offset:0 sc1
    v_mfma_f32_16x16x32_bf16 v[150:153], a[36:39], v[66:69], v[150:153]
    v_mfma_f32_16x16x32_bf16 v[154:157], a[40:43], v[66:69], v[154:157]
    v_mfma_f32_16x16x32_bf16 v[158:161], a[44:47], v[66:69], v[158:161]
    s_waitcnt vmcnt(11)
    v_mfma_f32_16x16x32_bf16 v[146:149], a[48:51], v[70:73], v[146:149]
    buffer_load_dwordx4 v[110:113], v1, s[4:7], s81 offen offset:1024 sc1
    v_mfma_f32_16x16x32_bf16 v[150:153], a[52:55], v[70:73], v[150:153]
    v_mfma_f32_16x16x32_bf16 v[154:157], a[56:59], v[70:73], v[154:157]
    v_mfma_f32_16x16x32_bf16 v[158:161], a[60:63], v[70:73], v[158:161]
    s_waitcnt vmcnt(11)
    v_mfma_f32_16x16x32_bf16 v[146:149], a[64:67], v[74:77], v[146:149]
    s_waitcnt vmcnt(8)
    s_mov_b64 exec, s[30:31]
    v_cmp_ne_u32 vcc, s47, v244
    s_mov_b64 exec, -1
    s_nop 2
    s_cbranch_vccz L_early_52
    s_mov_b64 s[94:95], s[30:31]
    v_add_u32 v253, 512, v243
    v_mov_b32 v244, v253
    s_mov_b64 exec, s[94:95]
    s_mov_b32 s49, 0
L_poll_53:
    buffer_load_dword v253, v244, s[4:7], 0 offen sc1
    s_waitcnt vmcnt(0)
    v_cmp_ne_u32 vcc, s47, v253
    s_nop 4
    s_cbranch_vccz L_polldone_54
    s_add_u32 s49, s49, 1
    s_cmp_lt_u32 s49, 200000
    s_cbranch_scc1 L_poll_53
    s_add_u32 s99, s99, 1
L_polldone_54:
    s_mov_b64 exec, -1
L_early_52:
    buffer_load_dwordx4 v[114:117], v1, s[4:7], s82 offen offset:0 sc1
    v_mfma_f32_16x16x32_bf16 v[150:153], a[68:71], v[74:77], v[150:153]
    v_mfma_f32_16x16x32_bf16 v[154:157], a[72:75], v[74:77], v[154:157]
    v_mfma_f32_16x16x32_bf16 v[158:161], a[76:79], v[74:77], v[158:161]
    s_waitcnt vmcnt(11)
    v_mfma_f32_16x16x32_bf16 v[146:149], a[80:83], v[78:81], v[146:149]
    buffer_load_dwordx4 v[118:121], v1, s[4:7], s82 offen offset:1024 sc1
    v_mfma_f32_16x16x32_bf16 v[150:153], a[84:87], v[78:81], v[150:153]
    v_mfma_f32_16x16x32_bf16 v[154:157], a[88:91], v[78:81], v[154:157]
    v_mfma_f32_16x16x32_bf16 v[158:161], a[92:95], v[78:81], v[158:161]
    s_waitcnt vmcnt(11)
    v_mfma_f32_16x16x32_bf16 v[146:149], a[96:99], v[82:85], v[146:149]
    buffer_load_dwordx4 v[122:125], v1, s[4:7], s82 offen offset:2048 sc1
    v_mfma_f32_16x16x32_bf16 v[150:153], a[100:103], v[82:85], v[150:153]
    v_mfma_f32_16x16x32_bf16 v[154:157], a[104:107], v[82:85], v[154:157]
    v_mfma_f32_16x16x32_bf16 v[158:161], a[108:111], v[82:85], v[158:161]
    s_waitcnt vmcnt(10)
    v_mfma_f32_16x16x32_bf16 v[146:149], a[112:115], v[86:89], v[146:149]
    buffer_load_dwordx4 v[126:129], v1, s[4:7], s82 offen offset:3072 sc1
    v_mfma_f32_16x16x32_bf16 v[150:153], a[116:119], v[86:89], v[150:153]
    v_mfma_f32_16x16x32_bf16 v[154:157], a[120:123], v[86:89], v[154:157]
    v_mfma_f32_16x16x32_bf16 v[158:161], a[124:127], v[86:89], v[158:161]
    s_waitcnt vmcnt(9)
    v_mfma_f32_16x16x32_bf16 v[146:149], a[128:131], v[90:93], v[146:149]
    buffer_load_dwordx4 v[66:69], v1, s[4:7], s83 offen offset:0 sc1
    v_mfma_f32_16x16x32_bf16 v[150:153], a[132:135], v[90:93], v[150:153]
    v_mfma_f32_16x16x32_bf16 v[154:157], a[136:139], v[90:93], v[154:157]
    v_mfma_f32_16x16x32_bf16 v[158:161], a[140:143], v[90:93], v[158:161]
    s_waitcnt vmcnt(9)
    v_mfma_f32_16x16x32_bf16 v[146:149], a[144:147], v[94:97], v[146:149]
    buffer_load_dwordx4 v[70:73], v1, s[4:7], s83 offen offset:1024 sc1
    v_mfma_f32_16x16x32_bf16 v[150:153], a[148:151], v[94:97], v[150:153]
    v_mfma_f32_16x16x32_bf16 v[154:157], a[152:155], v[94:97], v[154:157]
    v_mfma_f32_16x16x32_bf16 v[158:161], a[156:159], v[94:97], v[158:161]
    s_waitcnt vmcnt(9)
    v_mfma_f32_16x16x32_bf16 v[146:149], a[160:163], v[98:101], v[146:149]
    buffer_load_dwordx4 v[74:77], v1, s[4:7], s83 offen offset:2048 sc1
    s_mov_b64 exec, s[30:31]
    buffer_load_dword v244, v243, s[4:7], 0 offen offset:768 sc1
    s_mov_b64 exec, -1
    v_mfma_f32_16x16x32_bf16 v[150:153], a[164:167], v[98:101], v[150:153]
    v_mfma_f32_16x16x32_bf16 v[154:157], a[168:171], v[98:101], v[154:157]
    v_mfma_f32_16x16x32_bf16 v[158:161], a[172:175], v[98:101], v[158:161]
    s_waitcnt vmcnt(10)
    v_mfma_f32_16x16x32_bf16 v[146:149], a[176:179], v[102:105], v[146:149]
    buffer_load_dwordx4 v[78:81], v1, s[4:7], s83 offen offset:3072 sc1
    v_mfma_f32_16x16x32_bf16 v[150:153], a[180:183], v[102:105], v[150:153]
    v_mfma_f32_16x16x32_bf16 v[154:157], a[184:187], v[102:105], v[154:157]
    v_mfma_f32_16x16x32_bf16 v[158:161], a[188:191], v[102:105], v[158:161]
    s_waitcnt vmcnt(10)
    v_mfma_f32_16x16x32_bf16 v[146:149], a[192:195], v[106:109], v[146:149]
    buffer_load_dwordx4 v[82:85], v1, s[4:7], s84 offen offset:0 sc1
    v_mfma_f32_16x16x32_bf16 v[150:153], a[196:199], v[106:109], v[150:153]
    v_mfma_f32_16x16x32_bf16 v[154:157], a[200:203], v[106:109], v[154:157]
    v_mfma_f32_16x16x32_bf16 v[158:161], a[204:207], v[106:109], v[158:161]
    s_waitcnt vmcnt(10)
    v_mfma_f32_16x16x32_bf16 v[146:149], a[208:211], v[110:113], v[146:149]
    buffer_load_dwordx4 v[86:89], v1, s[4:7], s84 offen offset:1024 sc1
    v_mfma_f32_16x16x32_bf16 v[150:153], a[212:215], v[110:113], v[150:153]
    v_mfma_f32_16x16x32_bf16 v[154:157], a[216:219], v[110:113], v[154:157]
    v_mfma_f32_16x16x32_bf16 v[158:161], a[220:223], v[110:113], v[158:161]
    s_waitcnt vmcnt(10)
    v_mfma_f32_16x16x32_bf16 v[162:165], a[0:3], v[114:117], 0
    buffer_load_dwordx4 v[90:93], v1, s[4:7], s84 offen offset:2048 sc1
    v_mfma_f32_16x16x32_bf16 v[166:169], a[4:7], v[114:117], 0
    v_mfma_f32_16x16x32_bf16 v[170:173], a[8:11], v[114:117], 0
    v_mfma_f32_16x16x32_bf16 v[174:177], a[12:15], v[114:117], 0
    ds_write_b128 v248, v[146:149] offset:4096
    s_waitcnt vmcnt(10)
    v_mfma_f32_16x16x32_bf16 v[162:165], a[16:19], v[118:121], v[162:165]
    buffer_load_dwordx4 v[94:97], v1, s[4:7], s84 offen offset:3072 sc1
    v_mfma_f32_16x16x32_bf16 v[166:169], a[20:23], v[118:121], v[166:169]
    ds_write_b128 v248, v[150:153] offset:5120
    v_mfma_f32_16x16x32_bf16 v[170:173], a[24:27], v[118:121], v[170:173]
    ds_write_b128 v248, v[154:157] offset:6144
    v_mfma_f32_16x16x32_bf16 v[174:177], a[28:31], v[118:121], v[174:177]
    ds_write_b128 v248, v[158:161] offset:7168
    s_waitcnt vmcnt(10)
    v_mfma_f32_16x16x32_bf16 v[162:165], a[32:35], v[122:125], v[162:165]
    buffer_load_dwordx4 v[98:101], v1, s[4:7], s85 offen offset:0 sc1
    v_mfma_f32_16x16x32_bf16 v[166:169], a[36:39], v[122:125], v[166:169]
    v_mfma_f32_16x16x32_bf16 v[170:173], a[40:43], v[122:125], v[170:173]
    v_mfma_f32_16x16x32_bf16 v[174:177], a[44:47], v[122:125], v[174:177]
    s_waitcnt vmcnt(10)
    v_mfma_f32_16x16x32_bf16 v[162:165], a[48:51], v[126:129], v[162:165]
    buffer_load_dwordx4 v[102:105], v1, s[4:7], s85 offen offset:1024 sc1
    v_mfma_f32_16x16x32_bf16 v[166:169], a[52:55], v[126:129], v[166:169]
    v_mfma_f32_16x16x32_bf16 v[170:173], a[56:59], v[126:129], v[170:173]
    v_mfma_f32_16x16x32_bf16 v[174:177], a[60:63], v[126:129], v[174:177]
    s_waitcnt vmcnt(10)
    v_mfma_f32_16x16x32_bf16 v[162:165], a[64:67], v[66:69], v[162:165]
    s_waitcnt vmcnt(7)
    s_mov_b64 exec, s[30:31]
    v_cmp_ne_u32 vcc, s47, v244
    s_mov_b64 exec, -1
    s_nop 2
    s_cbranch_vccz L_early_55
    s_mov_b64 s[94:95], s[30:31]
    v_add_u32 v253, 768, v243
    v_mov_b32 v244, v253
    s_mov_b64 exec, s[94:95]
    s_mov_b32 s49, 0
L_poll_56:
    buffer_load_dword v253, v244, s[4:7], 0 offen sc1
    s_waitcnt vmcnt(0)
    v_cmp_ne_u32 vcc, s47, v253
    s_nop 4
    s_cbranch_vccz L_polldone_57
    s_add_u32 s49, s49, 1
    s_cmp_lt_u32 s49, 200000
    s_cbranch_scc1 L_poll_56
    s_add_u32 s99, s99, 1
L_polldone_57:
    s_mov_b64 exec, -1
L_early_55:
    buffer_load_dwordx4 v[106:109], v1, s[4:7], s86 offen offset:0 sc1
    v_mfma_f32_16x16x32_bf16 v[166:169], a[68:71], v[66:69], v[166:169]
    v_mfma_f32_16x16x32_bf16 v[170:173], a[72:75], v[66:69], v[170:173]
    v_mfma_f32_16x16x32_bf16 v[174:177], a[76:79], v[66:69], v[174:177]
    s_waitcnt vmcnt(10)
    v_mfma_f32_16x16x32_bf16 v[162:165], a[80:83], v[70:73], v[162:165]
    buffer_load_dwordx4 v[110:113], v1, s[4:7], s86 offen offset:1024 sc1
    v_mfma_f32_16x16x32_bf16 v[166:169], a[84:87], v[70:73], v[166:169]
    v_mfma_f32_16x16x32_bf16 v[170:173], a[88:91], v[70:73], v[170:173]
    v_mfma_f32_16x16x32_bf16 v[174:177], a[92:95], v[70:73], v[174:177]
    s_waitcnt vmcnt(10)
    v_mfma_f32_16x16x32_bf16 v[162:165], a[96:99], v[74:77], v[162:165]
    buffer_load_dwordx4 v[114:117], v1, s[4:7], s86 offen offset:2048 sc1
    v_mfma_f32_16x16x32_bf16 v[166:169], a[100:103], v[74:77], v[166:169]
    v_mfma_f32_16x16x32_bf16 v[170:173], a[104:107], v[74:77], v[170:173]
    v_mfma_f32_16x16x32_bf16 v[174:177], a[108:111], v[74:77], v[174:177]
    s_waitcnt vmcnt(9)
    v_mfma_f32_16x16x32_bf16 v[162:165], a[112:115], v[78:81], v[162:165]
    buffer_load_dwordx4 v[118:121], v1, s[4:7], s86 offen offset:3072 sc1
    v_mfma_f32_16x16x32_bf16 v[166:169], a[116:119], v[78:81], v[166:169]
    v_mfma_f32_16x16x32_bf16 v[170:173], a[120:123], v[78:81], v[170:173]
    v_mfma_f32_16x16x32_bf16 v[174:177], a[124:127], v[78:81], v[174:177]
    s_waitcnt vmcnt(9)
    v_mfma_f32_16x16x32_bf16 v[162:165], a[128:131], v[82:85], v[162:165]
    buffer_load_dwordx4 v[122:125], v1, s[4:7], s87 offen offset:0 sc1
    v_mfma_f32_16x16x32_bf16 v[166:169], a[132:135], v[82:85], v[166:169]
    v_mfma_f32_16x16x32_bf16 v[170:173], a[136:139], v[82:85], v[170:173]
    v_mfma_f32_16x16x32_bf16 v[174:177], a[140:143], v[82:85], v[174:177]
    s_waitcnt vmcnt(9)
    v_mfma_f32_16x16x32_bf16 v[162:165], a[144:147], v[86:89], v[162:165]
    buffer_load_dwordx4 v[126:129], v1, s[4:7], s87 offen offset:1024 sc1
    v_mfma_f32_16x16x32_bf16 v[166:169], a[148:151], v[86:89], v[166:169]
    v_mfma_f32_16x16x32_bf16 v[170:173], a[152:155], v[86:89], v[170:173]
    v_mfma_f32_16x16x32_bf16 v[174:177], a[156:159], v[86:89], v[174:177]
    s_waitcnt vmcnt(9)
    v_mfma_f32_16x16x32_bf16 v[162:165], a[160:163], v[90:93], v[162:165]
    buffer_load_dwordx4 v[66:69], v1, s[4:7], s87 offen offset:2048 sc1
    v_mfma_f32_16x16x32_bf16 v[166:169], a[164:167], v[90:93], v[166:169]
    v_mfma_f32_16x16x32_bf16 v[170:173], a[168:171], v[90:93], v[170:173]
    v_mfma_f32_16x16x32_bf16 v[174:177], a[172:175], v[90:93], v[174:177]
    s_waitcnt vmcnt(9)
    v_mfma_f32_16x16x32_bf16 v[162:165], a[176:179], v[94:97], v[162:165]
    buffer_load_dwordx4 v[70:73], v1, s[4:7], s87 offen offset:3072 sc1
    v_mfma_f32_16x16x32_bf16 v[166:169], a[180:183], v[94:97], v[166:169]
    v_mfma_f32_16x16x32_bf16 v[170:173], a[184:187], v[94:97], v[170:173]
    v_mfma_f32_16x16x32_bf16 v[174:177], a[188:191], v[94:97], v[174:177]
    s_waitcnt vmcnt(9)
    v_mfma_f32_16x16x32_bf16 v[162:165], a[192:195], v[98:101], v[162:165]
    buffer_load_dwordx4 v[74:77], v1, s[4:7], s88 offen offset:0 sc1
    v_mfma_f32_16x16x32_bf16 v[166:169], a[196:199], v[98:101], v[166:169]
    v_mfma_f32_16x16x32_bf16 v[170:173], a[200:203], v[98:101], v[170:173]
    v_mfma_f32_16x16x32_bf16 v[174:177], a[204:207], v[98:101], v[174:177]
    s_waitcnt vmcnt(9)
    v_mfma_f32_16x16x32_bf16 v[162:165], a[208:211], v[102:105], v[162:165]
    buffer_load_dwordx4 v[78:81], v1, s[4:7], s88 offen offset:1024 sc1
    v_mfma_f32_16x16x32_bf16 v[166:169], a[212:215], v[102:105], v[166:169]
    v_mfma_f32_16x16x32_bf16 v[170:173], a[216:219], v[102:105], v[170:173]
    v_mfma_f32_16x16x32_bf16 v[174:177], a[220:223], v[102:105], v[174:177]
    s_waitcnt vmcnt(9)
    v_mfma_f32_16x16x32_bf16 v[178:181], a[0:3], v[106:109], 0
    buffer_load_dwordx4 v[82:85], v1, s[4:7], s88 offen offset:2048 sc1
    v_mfma_f32_16x16x32_bf16 v[182:185], a[4:7], v[106:109], 0
    v_mfma_f32_16x16x32_bf16 v[186:189], a[8:11], v[106:109], 0
    v_mfma_f32_16x16x32_bf16 v[190:193], a[12:15], v[106:109], 0
    ds_write_b128 v248, v[162:165] offset:32768
    ds_write_b128 v248, v[166:169] offset:33792
    s_waitcnt vmcnt(9)
    v_mfma_f32_16x16x32_bf16 v[178:181], a[16:19], v[110:113], v[178:181]
    buffer_load_dwordx4 v[86:89], v1, s[4:7], s88 offen offset:3072 sc1
    v_mfma_f32_16x16x32_bf16 v[182:185], a[20:23], v[110:113], v[182:185]
    ds_write_b128 v248, v[170:173] offset:34816
    ds_write_b128 v248, v[174:177] offset:35840
    v_mfma_f32_16x16x32_bf16 v[186:189], a[24:27], v[110:113], v[186:189]
    s_waitcnt lgkmcnt(0)
    s_barrier
    ds_read_b128 v[194:197], v249 offset:0
    v_mfma_f32_16x16x32_bf16 v[190:193], a[28:31], v[110:113], v[190:193]
    ds_read_b128 v[198:201], v249 offset:1024
    ds_read_b128 v[202:205], v249 offset:8192
    s_waitcnt vmcnt(9)
    v_mfma_f32_16x16x32_bf16 v[178:181], a[32:35], v[114:117], v[178:181]
    buffer_load_dwordx4 v[90:93], v1, s[4:7], s89 offen offset:0 sc1
    v_mfma_f32_16x16x32_bf16 v[182:185], a[36:39], v[114:117], v[182:185]
    ds_read_b128 v[206:209], v249 offset:9216
    ds_read_b128 v[210:213], v249 offset:16384
    v_mfma_f32_16x16x32_bf16 v[186:189], a[40:43], v[114:117], v[186:189]
    ds_read_b128 v[214:217], v249 offset:17408
    ds_read_b128 v[218:221], v249 offset:24576
    v_mfma_f32_16x16x32_bf16 v[190:193], a[44:47], v[114:117], v[190:193]
    ds_read_b128 v[222:225], v249 offset:25600
    v_accvgpr_read_b32 v234, a224
    s_waitcnt vmcnt(9)
    v_mfma_f32_16x16x32_bf16 v[178:181], a[48:51], v[118:121], v[178:181]
    buffer_load_dwordx4 v[94:97], v1, s[4:7], s89 offen offset:1024 sc1
    v_mfma_f32_16x16x32_bf16 v[182:185], a[52:55], v[118:121], v[182:185]
    v_accvgpr_read_b32 v235, a225
    v_accvgpr_read_b32 v236, a226
    v_mfma_f32_16x16x32_bf16 v[186:189], a[56:59], v[118:121], v[186:189]
    v_accvgpr_read_b32 v237, a227
    v_lshlrev_b32 v226, 16, v234
    v_mfma_f32_16x16x32_bf16 v[190:193], a[60:63], v[118:121], v[190:193]
    v_and_b32 v227, 0xffff0000, v234
    v_lshlrev_b32 v228, 16, v235
    s_waitcnt vmcnt(9)
    v_mfma_f32_16x16x32_bf16 v[178:181], a[64:67], v[122:125], v[178:181]
    v_and_b32 v229, 0xffff0000, v235
    v_lshlrev_b32 v230, 16, v236
    v_mfma_f32_16x16x32_bf16 v[182:185], a[68:71], v[122:125], v[182:185]
    v_and_b32 v231, 0xffff0000, v236
    v_lshlrev_b32 v232, 16, v237
    v_mfma_f32_16x16x32_bf16 v[186:189], a[72:75], v[122:125], v[186:189]
    v_and_b32 v233, 0xffff0000, v237
    v_accvgpr_read_b32 v234, a232
    v_mfma_f32_16x16x32_bf16 v[190:193], a[76:79], v[122:125], v[190:193]
    v_accvgpr_read_b32 v235, a233
    v_accvgpr_read_b32 v236, a234
    s_waitcnt vmcnt(8)
    v_mfma_f32_16x16x32_bf16 v[178:181], a[80:83], v[126:129], v[178:181]
    v_accvgpr_read_b32 v237, a235
    v_accvgpr_read_b32 v238, a236
    v_mfma_f32_16x16x32_bf16 v[182:185], a[84:87], v[126:129], v[182:185]
    v_accvgpr_read_b32 v239, a237
    v_accvgpr_read_b32 v240, a238
    v_mfma_f32_16x16x32_bf16 v[186:189], a[88:91], v[126:129], v[186:189]
    v_accvgpr_read_b32 v241, a239
    v_add_f32 v226, v226, v234
    v_mfma_f32_16x16x32_bf16 v[190:193], a[92:95], v[126:129], v[190:193]
    v_add_f32 v227, v227, v235
    v_add_f32 v228, v228, v236
    s_waitcnt vmcnt(7)
    v_mfma_f32_16x16x32_bf16 v[178:181], a[96:99], v[66:69], v[178:181]
    v_add_f32 v229, v229, v237
    v_add_f32 v230, v230, v238
    v_mfma_f32_16x16x32_bf16 v[182:185], a[100:103], v[66:69], v[182:185]
    v_add_f32 v231, v231, v239
    v_add_f32 v232, v232, v240
    v_mfma_f32_16x16x32_bf16 v[186:189], a[104:107], v[66:69], v[186:189]
    v_add_f32 v233, v233, v241
    s_waitcnt lgkmcnt(0)
    v_mfma_f32_16x16x32_bf16 v[190:193], a[108:111], v[66:69], v[190:193]
    v_add_f32 v194, v194, v202
    v_add_f32 v195, v195, v203
    s_waitcnt vmcnt(6)
    v_mfma_f32_16x16x32_bf16 v[178:181], a[112:115], v[70:73], v[178:181]
    v_add_f32 v196, v196, v204
    v_add_f32 v197, v197, v205
    v_mfma_f32_16x16x32_bf16 v[182:185], a[116:119], v[70:73], v[182:185]
    v_add_f32 v198, v198, v206
    v_add_f32 v199, v199, v207
    v_mfma_f32_16x16x32_bf16 v[186:189], a[120:123], v[70:73], v[186:189]
    v_add_f32 v200, v200, v208
    v_add_f32 v201, v201, v209
    v_mfma_f32_16x16x32_bf16 v[190:193], a[124:127], v[70:73], v[190:193]
    v_add_f32 v210, v210, v218
    v_add_f32 v211, v211, v219
    s_waitcnt vmcnt(5)
    v_mfma_f32_16x16x32_bf16 v[178:181], a[128:131], v[74:77], v[178:181]
    v_add_f32 v212, v212, v220
    v_add_f32 v213, v213, v221
    v_mfma_f32_16x16x32_bf16 v[182:185], a[132:135], v[74:77], v[182:185]
    v_add_f32 v214, v214, v222
    v_add_f32 v215, v215, v223
    v_mfma_f32_16x16x32_bf16 v[186:189], a[136:139], v[74:77], v[186:189]
    v_add_f32 v216, v216, v224
    v_add_f32 v217, v217, v225
    v_mfma_f32_16x16x32_bf16 v[190:193], a[140:143], v[74:77], v[190:193]
    v_add_f32 v194, v194, v210
    v_add_f32 v195, v195, v211
    s_waitcnt vmcnt(4)
    v_mfma_f32_16x16x32_bf16 v[178:181], a[144:147], v[78:81], v[178:181]
    v_add_f32 v196, v196, v212
    v_add_f32 v197, v197, v213
    v_mfma_f32_16x16x32_bf16 v[182:185], a[148:151], v[78:81], v[182:185]
    v_add_f32 v198, v198, v214
    v_add_f32 v199, v199, v215
    v_mfma_f32_16x16x32_bf16 v[186:189], a[152:155], v[78:81], v[186:189]
    v_add_f32 v200, v200, v216
    v_add_f32 v201, v201, v217
    v_mfma_f32_16x16x32_bf16 v[190:193], a[156:159], v[78:81], v[190:193]
    v_add_f32 v226, v226, v194
    v_add_f32 v227, v227, v195
    s_waitcnt vmcnt(3)
    v_mfma_f32_16x16x32_bf16 v[178:181], a[160:163], v[82:85], v[178:181]
    v_add_f32 v228, v228, v196
    v_add_f32 v229, v229, v197
    v_mfma_f32_16x16x32_bf16 v[182:185], a[164:167], v[82:85], v[182:185]
    v_add_f32 v230, v230, v198
    v_add_f32 v231, v231, v199
    v_mfma_f32_16x16x32_bf16 v[186:189], a[168:171], v[82:85], v[186:189]
    v_add_f32 v232, v232, v200
    v_add_f32 v233, v233, v201
    v_mfma_f32_16x16x32_bf16 v[190:193], a[172:175], v[82:85], v[190:193]
    v_cvt_pk_bf16_f32 v18, v226, v227
    v_cvt_pk_bf16_f32 v19, v228, v229
    s_waitcnt vmcnt(2)
    v_mfma_f32_16x16x32_bf16 v[178:181], a[176:179], v[86:89], v[178:181]
    v_cvt_pk_bf16_f32 v20, v230, v231
    v_cvt_pk_bf16_f32 v21, v232, v233
    v_mfma_f32_16x16x32_bf16 v[182:185], a[180:183], v[86:89], v[182:185]
    v_accvgpr_write_b32 a224, v18
    v_accvgpr_write_b32 a225, v19
    v_mfma_f32_16x16x32_bf16 v[186:189], a[184:187], v[86:89], v[186:189]
    v_accvgpr_write_b32 a226, v20
    v_accvgpr_write_b32 a227, v21
    v_mfma_f32_16x16x32_bf16 v[190:193], a[188:191], v[86:89], v[190:193]
    s_cmp_eq_u32 s48, 0
    s_cbranch_scc0 L_dfin_58
    buffer_store_dwordx4 v[18:21], v1, s[4:7], s36 offen offset:0 sc1
    s_branch L_ddone_59
L_dfin_58:
    s_nop 1
    v_permlane16_swap_b32 v18, v20
    v_permlane16_swap_b32 v19, v21
    buffer_store_dwordx4 v[18:21], v242, s[16:19], s36 offen
L_ddone_59:
    s_waitcnt vmcnt(2)
    v_mfma_f32_16x16x32_bf16 v[178:181], a[192:195], v[90:93], v[178:181]
    v_mfma_f32_16x16x32_bf16 v[182:185], a[196:199], v[90:93], v[182:185]
    v_mfma_f32_16x16x32_bf16 v[186:189], a[200:203], v[90:93], v[186:189]
    v_mfma_f32_16x16x32_bf16 v[190:193], a[204:207], v[90:93], v[190:193]
    s_waitcnt vmcnt(1)
    v_mfma_f32_16x16x32_bf16 v[178:181], a[208:211], v[94:97], v[178:181]
    v_mfma_f32_16x16x32_bf16 v[182:185], a[212:215], v[94:97], v[182:185]
    v_mfma_f32_16x16x32_bf16 v[186:189], a[216:219], v[94:97], v[186:189]
    v_mfma_f32_16x16x32_bf16 v[190:193], a[220:223], v[94:97], v[190:193]
    s_nop 4
    ds_write_b128 v248, v[178:181] offset:36864
    ds_write_b128 v248, v[182:185] offset:37888
    ds_write_b128 v248, v[186:189] offset:38912
    ds_write_b128 v248, v[190:193] offset:39936
    v_accvgpr_read_b32 v10, a228
    v_accvgpr_read_b32 v11, a229
    v_accvgpr_read_b32 v12, a230
    v_accvgpr_read_b32 v13, a231
    v_lshlrev_b32 v2, 16, v10
    v_and_b32 v3, 0xffff0000, v10
    v_lshlrev_b32 v4, 16, v11
    v_and_b32 v5, 0xffff0000, v11
    v_lshlrev_b32 v6, 16, v12
    v_and_b32 v7, 0xffff0000, v12
    v_lshlrev_b32 v8, 16, v13
    v_and_b32 v9, 0xffff0000, v13
    v_accvgpr_read_b32 v10, a232
    v_accvgpr_read_b32 v11, a233
    v_accvgpr_read_b32 v12, a234
    v_accvgpr_read_b32 v13, a235
    v_accvgpr_read_b32 v14, a236
    v_accvgpr_read_b32 v15, a237
    v_accvgpr_read_b32 v16, a238
    v_accvgpr_read_b32 v17, a239
    v_add_f32 v2, v2, v10
    v_add_f32 v3, v3, v11
    v_add_f32 v4, v4, v12
    v_add_f32 v5, v5, v13
    v_add_f32 v6, v6, v14
    v_add_f32 v7, v7, v15
    v_add_f32 v8, v8, v16
    v_add_f32 v9, v9, v17
    s_waitcnt lgkmcnt(0)
    s_barrier
    ds_read_b128 v[194:197], v249 offset:32768
    ds_read_b128 v[198:201], v249 offset:33792
    ds_read_b128 v[202:205], v249 offset:40960
    ds_read_b128 v[206:209], v249 offset:41984
    ds_read_b128 v[210:213], v249 offset:49152
    ds_read_b128 v[214:217], v249 offset:50176
    ds_read_b128 v[218:221], v249 offset:57344
    ds_read_b128 v[222:225], v249 offset:58368
    s_waitcnt lgkmcnt(0)
    v_pk_add_f32 v[194:195], v[194:195], v[202:203]
    v_pk_add_f32 v[196:197], v[196:197], v[204:205]
    v_pk_add_f32 v[198:199], v[198:199], v[206:207]
    v_pk_add_f32 v[200:201], v[200:201], v[208:209]
    v_pk_add_f32 v[210:211], v[210:211], v[218:219]
    v_pk_add_f32 v[212:213], v[212:213], v[220:221]
    v_pk_add_f32 v[214:215], v[214:215], v[222:223]
    v_pk_add_f32 v[216:217], v[216:217], v[224:225]
    v_pk_add_f32 v[194:195], v[194:195], v[210:211]
    v_pk_add_f32 v[196:197], v[196:197], v[212:213]
    v_pk_add_f32 v[198:199], v[198:199], v[214:215]
    v_pk_add_f32 v[200:201], v[200:201], v[216:217]
    v_pk_add_f32 v[2:3], v[2:3], v[194:195]
    v_pk_add_f32 v[4:5], v[4:5], v[196:197]
    v_pk_add_f32 v[6:7], v[6:7], v[198:199]
    v_pk_add_f32 v[8:9], v[8:9], v[200:201]
    v_cvt_pk_bf16_f32 v22, v2, v3
    v_cvt_pk_bf16_f32 v23, v4, v5
    v_cvt_pk_bf16_f32 v24, v6, v7
    v_cvt_pk_bf16_f32 v25, v8, v9
    v_accvgpr_write_b32 a228, v22
    v_accvgpr_write_b32 a229, v23
    v_accvgpr_write_b32 a230, v24
    v_accvgpr_write_b32 a231, v25
    s_cmp_eq_u32 s48, 0
    s_cbranch_scc0 L_dfin_60
    buffer_store_dwordx4 v[22:25], v1, s[4:7], s33 offen offset:0 sc1
    s_branch L_ddone_61
L_dfin_60:
    s_nop 1
    v_permlane16_swap_b32 v22, v24
    v_permlane16_swap_b32 v23, v25
    buffer_store_dwordx4 v[22:25], v242, s[16:19], s33 offen
L_ddone_61:
    s_cmp_eq_u32 s48, 0
    s_cbranch_scc0 L_next_pair
    v_and_b32 v250, 15, v0
    v_lshlrev_b32 v32, 3, v250
    v_pk_add_f32 v[28:29], v[226:227], v[228:229]
    v_pk_add_f32 v[30:31], v[230:231], v[232:233]
    v_pk_add_f32 v[28:29], v[28:29], v[30:31]
    v_add_f32 v36, v28, v29
    v_pk_mul_f32 v[28:29], v[226:227], v[226:227]
    v_pk_fma_f32 v[28:29], v[228:229], v[228:229], v[28:29]
    v_pk_fma_f32 v[28:29], v[230:231], v[230:231], v[28:29]
    v_pk_fma_f32 v[28:29], v[232:233], v[232:233], v[28:29]
    v_add_f32 v37, v28, v29
    v_mov_b32 v28, v36
    v_mov_b32 v29, v37
    s_nop 0
    v_permlane32_swap_b32 v36, v28
    v_permlane32_swap_b32 v37, v29
    v_add_f32 v36, v36, v28
    v_add_f32 v37, v37, v29
    v_mov_b32 v28, v36
    v_mov_b32 v29, v37
    s_nop 0
    v_permlane16_swap_b32 v36, v28
    v_permlane16_swap_b32 v37, v29
    v_add_f32 v36, v36, v28
    v_add_f32 v37, v37, v29
    v_pk_add_f32 v[28:29], v[2:3], v[4:5]
    v_pk_add_f32 v[30:31], v[6:7], v[8:9]
    v_pk_add_f32 v[28:29], v[28:29], v[30:31]
    v_add_f32 v38, v28, v29
    v_pk_mul_f32 v[28:29], v[2:3], v[2:3]
    v_pk_fma_f32 v[28:29], v[4:5], v[4:5], v[28:29]
    v_pk_fma_f32 v[28:29], v[6:7], v[6:7], v[28:29]
    v_pk_fma_f32 v[28:29], v[8:9], v[8:9], v[28:29]
    v_add_f32 v39, v28, v29
    v_mov_b32 v28, v38
    v_mov_b32 v29, v39
    s_nop 0
    v_permlane32_swap_b32 v38, v28
    v_permlane32_swap_b32 v39, v29
    v_add_f32 v38, v38, v28
    v_add_f32 v39, v39, v29
    v_mov_b32 v28, v38
    v_mov_b32 v29, v39
    s_nop 0
    v_permlane16_swap_b32 v38, v28
    v_permlane16_swap_b32 v39, v29
    v_add_f32 v38, v38, v28
    v_add_f32 v39, v39, v29
    s_mov_b64 exec, 0xffff
    buffer_store_dwordx2 v[36:37], v32, s[4:7], s37 offen sc1
    s_add_u32 s37, s37, 3584
    buffer_store_dwordx2 v[38:39], v32, s[4:7], s37 offen sc1
    s_mov_b64 exec, -1
    v_mov_b32 v240, s20
    v_lshlrev_b32 v241, 8, v0
    v_add_u32 v241, s28, v241
    s_waitcnt vmcnt(0)
    s_mov_b64 exec, 3
    s_cmp_eq_u32 s26, 0
    s_cbranch_scc1 L_slow_62
    buffer_store_dword v254, v241, s[4:7], 0 offen
    s_branch L_st_63
L_slow_62:
    buffer_store_dword v254, v241, s[4:7], 0 offen sc1
L_st_63:
    s_mov_b64 exec, -1
    s_mov_b64 exec, 1
    buffer_store_dword v254, v240, s[4:7], 0 offen sc1
    s_mov_b64 exec, -1
L_next_pair:
    s_add_u32 s48, s48, 1
    s_cmp_lt_u32 s48, 2
    s_cbranch_scc1 L_pair
L_end:
    s_endpgm
L_pair:
    s_mul_i32 s90, s48, 16384
    s_add_u32 s90, s90, 12288
    s_lshl_b32 s91, s98, 7
    s_add_u32 s90, s90, s91
    s_sub_u32 s90, s90, 128
    v_and_b32 v2, 48, v0
    v_add_u32 v2, v2, v0
    v_lshl_add_u32 v2, v2, 2, s90
    s_mov_b32 s94, 0x3fff3fff
    s_mov_b32 s95, 0x3fff
    s_cmp_eq_u32 s98, 0
    s_cselect_b32 s94, 0x3fff0000, s94
    s_mov_b32 s94, 0x3fff0000
    s_mov_b64 exec, s[94:95]
    s_mov_b32 s49, 0
L_poll_1:
    buffer_load_dword v253, v2, s[4:7], 0 offen sc1
    s_waitcnt vmcnt(0)
    v_cmp_ne_u32 vcc, s47, v253
    s_nop 4
    s_cbranch_vccz L_polldone_2
    s_add_u32 s49, s49, 1
    s_cmp_lt_u32 s49, 200000
    s_cbranch_scc1 L_poll_1
    s_add_u32 s99, s99, 1
L_polldone_2:
    s_mov_b64 exec, -1
    s_mul_i32 s90, s48, 1835008
    s_add_u32 s90, s90, 5246976
    s_mul_i32 s91, s98, 14336
    s_add_u32 s78, s90, s91
    s_add_u32 s82, s78, 14336
    s_add_u32 s79, s78, 4096
    s_add_u32 s80, s78, 8192
    s_add_u32 s81, s78, 12288
    s_add_u32 s83, s82, 4096
    s_add_u32 s84, s82, 8192
    s_add_u32 s85, s82, 12288
    s_lshl_b32 s91, s42, 3
    s_max_u32 s91, s91, 1
    s_sub_u32 s91, s91, 1
    s_mul_i32 s91, s91, 14336
    s_add_u32 s74, s90, s91
    s_lshl_b32 s91, s46, 12
    s_add_u32 s74, s74, s91
    s_add_u32 s75, s91, 86016
    buffer_load_dwordx4 v[114:117], v1, s[4:7], s78 offen offset:0 sc1
    buffer_load_dwordx4 v[118:121], v1, s[4:7], s82 offen offset:0 sc1
    buffer_load_dwordx4 v[122:125], v1, s[4:7], s78 offen offset:1024 sc1
    buffer_load_dwordx4 v[126:129], v1, s[4:7], s82 offen offset:1024 sc1
    buffer_load_dwordx4 v[130:133], v1, s[4:7], s78 offen offset:2048 sc1
    buffer_load_dwordx4 v[134:137], v1, s[4:7], s82 offen offset:2048 sc1
    buffer_load_dwordx4 v[138:141], v1, s[4:7], s78 offen offset:3072 sc1
    buffer_load_dwordx4 v[142:145], v1, s[4:7], s82 offen offset:3072 sc1
    s_mov_b32 s27, 0
    s_mov_b32 s25, 0
    s_mul_i32 s90, s48, 229376
    s_add_u32 s90, s90, 8916992
    s_mul_i32 s91, s98, 1792
    s_add_u32 s87, s90, s91
    s_add_u32 s88, s87, 1792
    s_sub_u32 s86, s87, 1792
    s_cmp_eq_u32 s98, 0
    s_cselect_b32 s86, s87, s86
    v_and_b32 v250, 15, v0
    v_lshrrev_b32 v251, 4, v0
    v_lshlrev_b32 v240, 3, v250
    v_lshl_add_u32 v240, v251, 7, v240
    v_mov_b32 v242, 0x80000000
    v_cmp_lt_u32 vcc, 1, v251
    s_nop 1
    v_cndmask_b32 v241, 0, v242, vcc
    v_or_b32 v241, v241, v240
    v_add_u32 v243, 57344, v1
    v_lshlrev_b32 v244, 4, v251
    v_add_u32 v244, 151552, v244
    v_lshlrev_b32 v245, 2, v250
    v_add_u32 v245, 151552, v245
    s_mul_i32 s90, s46, 384
    s_add_u32 s90, s90, 153088
    v_lshl_add_u32 v162, v250, 2, s90
    v_lshl_add_u32 v163, v251, 4, s90
    s_lshl_b32 s90, s45, 7
    s_add_u32 s90, s90, 8192
    v_lshl_add_u32 v248, v0, 2, s90
    s_lshr_b32 s91, s46, 1
    s_lshl_b32 s92, s44, 2
    s_add_u32 s91, s91, s92
    s_lshl_b32 s91, s91, 5
    s_and_b32 s90, s46, 1
    s_add_u32 s91, s91, s90
    s_min_u32 s90, s45, 6
    s_lshl_b32 s90, s90, 1
    s_add_u32 s91, s91, s90
    s_lshl_b32 s91, s91, 2
    s_add_u32 s91, s91, 4096
    v_lshl_add_u32 v249, v0, 8, s91
    v_cmp_lt_u32 vcc, 31, v0
    s_nop 1
    v_cndmask_b32 v248, v248, v249, vcc
    s_lshr_b32 s90, s43, 3
    s_mul_i32 s90, s90, 7
    s_min_u32 s91, s45, 6
    s_add_u32 s90, s90, s91
    s_mul_i32 s90, s90, 112
    s_add_u32 s90, s90, 184184
    v_lshl_add_u32 v249, v0, 2, s90
    v_cmp_lt_u32 vcc, 33, v0
    s_nop 1
    v_cndmask_b32 v248, v248, v249, vcc
    s_lshl_b32 s90, s42, 7
    s_add_u32 s90, s90, 176128
    v_and_b32 v247, 15, v0
    v_lshl_add_u32 v247, v247, 2, s90
    s_lshl_b32 s91, s98, 7
    s_add_u32 s91, s91, 28544
    v_lshl_add_u32 v253, v0, 2, s91
    s_cmp_eq_u32 s46, 0
    s_cselect_b32 s90, 0, 16
    v_cmp_gt_u32 vcc, s90, v0
    s_nop 1
    v_cndmask_b32 v247, v247, v253, vcc
    s_mov_b32 s30, 0x3fff3fff
    s_mov_b32 s31, 0
    s_cmp_eq_u32 s42, 0
    s_cselect_b32 s30, 0x3fff, s30
    v_and_b32 v253, 15, v0
    v_lshlrev_b32 v253, 2, v253
    v_add_u32 v253, 28672, v253
    s_cmp_eq_u32 s98, 0
    s_cselect_b64 vcc, -1, 0
    v_cndmask_b32 v247, v247, v253, vcc
    ds_read_b128 v[66:69], v1 offset:0
    ds_read_b128 v[70:73], v1 offset:14336
    ds_read_b128 v[74:77], v1 offset:28672
    ds_read_b128 v[78:81], v1 offset:43008
    ds_read_b128 v[82:85], v243 offset:0
    ds_read_b128 v[86:89], v243 offset:14336
    s_waitcnt vmcnt(6)
    s_waitcnt lgkmcnt(0)
    v_mfma_f32_16x16x32_bf16 v[2:5], v[66:69], v[114:117], 0
    ds_read_b128 v[90:93], v1 offset:1024
    v_mfma_f32_16x16x32_bf16 v[6:9], v[70:73], v[114:117], 0
    ds_read_b128 v[94:97], v1 offset:15360
    v_mfma_f32_16x16x32_bf16 v[10:13], v[66:69], v[118:121], 0
    ds_read_b128 v[98:101], v1 offset:29696
    v_mfma_f32_16x16x32_bf16 v[14:17], v[70:73], v[118:121], 0
    ds_read_b128 v[102:105], v1 offset:44032
    v_mfma_f32_16x16x32_bf16 v[18:21], v[74:77], v[114:117], 0
    ds_read_b128 v[106:109], v243 offset:1024
    v_mfma_f32_16x16x32_bf16 v[22:25], v[78:81], v[114:117], 0
    ds_read_b128 v[110:113], v243 offset:15360
    v_mfma_f32_16x16x32_bf16 v[26:29], v[74:77], v[118:121], 0
    buffer_load_dwordx4 v[146:149], v1, s[4:7], s79 offen offset:0 sc1
    v_mfma_f32_16x16x32_bf16 v[30:33], v[78:81], v[118:121], 0
    v_mfma_f32_16x16x32_bf16 v[34:37], v[114:117], v[82:85], 0
    v_mfma_f32_16x16x32_bf16 v[38:41], v[114:117], v[86:89], 0
    buffer_load_dwordx4 v[150:153], v1, s[4:7], s83 offen offset:0 sc1
    v_mfma_f32_16x16x32_bf16 v[42:45], v[118:121], v[82:85], 0
    v_mfma_f32_16x16x32_bf16 v[46:49], v[118:121], v[86:89], 0
    s_waitcnt vmcnt(6)
    s_waitcnt lgkmcnt(0)
    v_mfma_f32_16x16x32_bf16 v[2:5], v[90:93], v[122:125], v[2:5]
    ds_read_b128 v[66:69], v1 offset:2048
    v_mfma_f32_16x16x32_bf16 v[6:9], v[94:97], v[122:125], v[6:9]
    ds_read_b128 v[70:73], v1 offset:16384
    v_mfma_f32_16x16x32_bf16 v[10:13], v[90:93], v[126:129], v[10:13]
    ds_read_b128 v[74:77], v1 offset:30720
    v_mfma_f32_16x16x32_bf16 v[14:17], v[94:97], v[126:129], v[14:17]
    ds_read_b128 v[78:81], v1 offset:45056
    v_mfma_f32_16x16x32_bf16 v[18:21], v[98:101], v[122:125], v[18:21]
    ds_read_b128 v[82:85], v243 offset:2048
    v_mfma_f32_16x16x32_bf16 v[22:25], v[102:105], v[122:125], v[22:25]
    ds_read_b128 v[86:89], v243 offset:16384
    v_mfma_f32_16x16x32_bf16 v[26:29], v[98:101], v[126:129], v[26:29]
    buffer_load_dwordx4 v[154:157], v1, s[4:7], s79 offen offset:1024 sc1
    v_mfma_f32_16x16x32_bf16 v[30:33], v[102:105], v[126:129], v[30:33]
    v_mfma_f32_16x16x32_bf16 v[34:37], v[122:125], v[106:109], v[34:37]
    v_mfma_f32_16x16x32_bf16 v[38:41], v[122:125], v[110:113], v[38:41]
    buffer_load_dwordx4 v[158:161], v1, s[4:7], s83 offen offset:1024 sc1
    v_mfma_f32_16x16x32_bf16 v[42:45], v[126:129], v[106:109], v[42:45]
    v_mfma_f32_16x16x32_bf16 v[46:49], v[126:129], v[110:113], v[46:49]
    s_waitcnt vmcnt(6)
    s_waitcnt lgkmcnt(0)
    v_mfma_f32_16x16x32_bf16 v[2:5], v[66:69], v[130:133], v[2:5]
    ds_read_b128 v[90:93], v1 offset:3072
    v_mfma_f32_16x16x32_bf16 v[6:9], v[70:73], v[130:133], v[6:9]
    ds_read_b128 v[94:97], v1 offset:17408
    v_mfma_f32_16x16x32_bf16 v[10:13], v[66:69], v[134:137], v[10:13]
    ds_read_b128 v[98:101], v1 offset:31744
    v_mfma_f32_16x16x32_bf16 v[14:17], v[70:73], v[134:137], v[14:17]
    ds_read_b128 v[102:105], v1 offset:46080
    v_mfma_f32_16x16x32_bf16 v[18:21], v[74:77], v[130:133], v[18:21]
    ds_read_b128 v[106:109], v243 offset:3072
    v_mfma_f32_16x16x32_bf16 v[22:25], v[78:81], v[130:133], v[22:25]
    ds_read_b128 v[110:113], v243 offset:17408
    v_mfma_f32_16x16x32_bf16 v[26:29], v[74:77], v[134:137], v[26:29]
    buffer_load_dwordx4 v[114:117], v1, s[4:7], s79 offen offset:2048 sc1
    v_mfma_f32_16x16x32_bf16 v[30:33], v[78:81], v[134:137], v[30:33]
    v_mfma_f32_16x16x32_bf16 v[34:37], v[130:133], v[82:85], v[34:37]
    buffer_load_dwordx2 v[218:219], v240, s[4:7], s87 offen offset:0 sc1
    v_mfma_f32_16x16x32_bf16 v[38:41], v[130:133], v[86:89], v[38:41]
    buffer_load_dwordx4 v[118:121], v1, s[4:7], s83 offen offset:2048 sc1
    v_mfma_f32_16x16x32_bf16 v[42:45], v[134:137], v[82:85], v[42:45]
    v_mfma_f32_16x16x32_bf16 v[46:49], v[134:137], v[86:89], v[46:49]
    buffer_load_dwordx2 v[220:221], v240, s[4:7], s87 offen offset:512 sc1
    s_waitcnt vmcnt(8)
    s_waitcnt lgkmcnt(0)
    v_mfma_f32_16x16x32_bf16 v[2:5], v[90:93], v[138:141], v[2:5]
    ds_read_b128 v[66:69], v1 offset:4096
    v_mfma_f32_16x16x32_bf16 v[6:9], v[94:97], v[138:141], v[6:9]
    ds_read_b128 v[70:73], v1 offset:18432
    v_mfma_f32_16x16x32_bf16 v[10:13], v[90:93], v[142:145], v[10:13]
    ds_read_b128 v[74:77], v1 offset:32768
    v_mfma_f32_16x16x32_bf16 v[14:17], v[94:97], v[142:145], v[14:17]
    ds_read_b128 v[78:81], v1 offset:47104
    v_mfma_f32_16x16x32_bf16 v[18:21], v[98:101], v[138:141], v[18:21]
    ds_read_b128 v[82:85], v243 offset:4096
    v_mfma_f32_16x16x32_bf16 v[22:25], v[102:105], v[138:141], v[22:25]
    ds_read_b128 v[86:89], v243 offset:18432
    v_mfma_f32_16x16x32_bf16 v[26:29], v[98:101], v[142:145], v[26:29]
    buffer_load_dwordx4 v[122:125], v1, s[4:7], s79 offen offset:3072 sc1
    v_mfma_f32_16x16x32_bf16 v[30:33], v[102:105], v[142:145], v[30:33]
    v_mfma_f32_16x16x32_bf16 v[34:37], v[138:141], v[106:109], v[34:37]
    buffer_load_dwordx2 v[222:223], v240, s[4:7], s87 offen offset:1024 sc1
    v_mfma_f32_16x16x32_bf16 v[38:41], v[138:141], v[110:113], v[38:41]
    buffer_load_dwordx4 v[126:129], v1, s[4:7], s83 offen offset:3072 sc1
    v_mfma_f32_16x16x32_bf16 v[42:45], v[142:145], v[106:109], v[42:45]
    v_mfma_f32_16x16x32_bf16 v[46:49], v[142:145], v[110:113], v[46:49]
    buffer_load_dwordx2 v[224:225], v241, s[4:7], s87 offen offset:1536 sc1
    s_waitcnt vmcnt(10)
    s_waitcnt lgkmcnt(0)
    v_mfma_f32_16x16x32_bf16 v[2:5], v[66:69], v[146:149], v[2:5]
    ds_read_b128 v[90:93], v1 offset:5120
    v_mfma_f32_16x16x32_bf16 v[6:9], v[70:73], v[146:149], v[6:9]
    ds_read_b128 v[94:97], v1 offset:19456
    v_mfma_f32_16x16x32_bf16 v[10:13], v[66:69], v[150:153], v[10:13]
    ds_read_b128 v[98:101], v1 offset:33792
    v_mfma_f32_16x16x32_bf16 v[14:17], v[70:73], v[150:153], v[14:17]
    ds_read_b128 v[102:105], v1 offset:48128
    v_mfma_f32_16x16x32_bf16 v[18:21], v[74:77], v[146:149], v[18:21]
    ds_read_b128 v[106:109], v243 offset:5120
    v_mfma_f32_16x16x32_bf16 v[22:25], v[78:81], v[146:149], v[22:25]
    ds_read_b128 v[110:113], v243 offset:19456
    v_mfma_f32_16x16x32_bf16 v[26:29], v[74:77], v[150:153], v[26:29]
    buffer_load_dwordx4 v[130:133], v1, s[4:7], s80 offen offset:0 sc1
    v_mfma_f32_16x16x32_bf16 v[30:33], v[78:81], v[150:153], v[30:33]
    v_mfma_f32_16x16x32_bf16 v[34:37], v[146:149], v[82:85], v[34:37]
    buffer_load_dwordx2 v[226:227], v240, s[4:7], s88 offen offset:0 sc1
    v_mfma_f32_16x16x32_bf16 v[38:41], v[146:149], v[86:89], v[38:41]
    buffer_load_dwordx4 v[134:137], v1, s[4:7], s84 offen offset:0 sc1
    v_mfma_f32_16x16x32_bf16 v[42:45], v[150:153], v[82:85], v[42:45]
    v_mfma_f32_16x16x32_bf16 v[46:49], v[150:153], v[86:89], v[46:49]
    buffer_load_dwordx2 v[228:229], v240, s[4:7], s88 offen offset:512 sc1
    s_waitcnt vmcnt(12)
    s_waitcnt lgkmcnt(0)
    v_mfma_f32_16x16x32_bf16 v[2:5], v[90:93], v[154:157], v[2:5]
    ds_read_b128 v[66:69], v1 offset:6144
    v_mfma_f32_16x16x32_bf16 v[6:9], v[94:97], v[154:157], v[6:9]
    ds_read_b128 v[70:73], v1 offset:20480
    v_mfma_f32_16x16x32_bf16 v[10:13], v[90:93], v[158:161], v[10:13]
    ds_read_b128 v[74:77], v1 offset:34816
    v_mfma_f32_16x16x32_bf16 v[14:17], v[94:97], v[158:161], v[14:17]
    ds_read_b128 v[78:81], v1 offset:49152
    v_mfma_f32_16x16x32_bf16 v[18:21], v[98:101], v[154:157], v[18:21]
    ds_read_b128 v[82:85], v243 offset:6144
    v_mfma_f32_16x16x32_bf16 v[22:25], v[102:105], v[154:157], v[22:25]
    ds_read_b128 v[86:89], v243 offset:20480
    v_mfma_f32_16x16x32_bf16 v[26:29], v[98:101], v[158:161], v[26:29]
    buffer_load_dwordx4 v[138:141], v1, s[4:7], s80 offen offset:1024 sc1
    v_mfma_f32_16x16x32_bf16 v[30:33], v[102:105], v[158:161], v[30:33]
    v_mfma_f32_16x16x32_bf16 v[34:37], v[154:157], v[106:109], v[34:37]
    buffer_load_dwordx2 v[230:231], v240, s[4:7], s88 offen offset:1024 sc1
    v_mfma_f32_16x16x32_bf16 v[38:41], v[154:157], v[110:113], v[38:41]
    buffer_load_dwordx4 v[142:145], v1, s[4:7], s84 offen offset:1024 sc1
    v_mfma_f32_16x16x32_bf16 v[42:45], v[158:161], v[106:109], v[42:45]
    v_mfma_f32_16x16x32_bf16 v[46:49], v[158:161], v[110:113], v[46:49]
    buffer_load_dwordx2 v[232:233], v241, s[4:7], s88 offen offset:1536 sc1
    s_waitcnt vmcnt(13)
    s_waitcnt lgkmcnt(0)
    v_mfma_f32_16x16x32_bf16 v[2:5], v[66:69], v[114:117], v[2:5]
    ds_read_b128 v[90:93], v1 offset:7168
    v_mfma_f32_16x16x32_bf16 v[6:9], v[70:73], v[114:117], v[6:9]
    ds_read_b128 v[94:97], v1 offset:21504
    v_mfma_f32_16x16x32_bf16 v[10:13], v[66:69], v[118:121], v[10:13]
    ds_read_b128 v[98:101], v1 offset:35840
    v_mfma_f32_16x16x32_bf16 v[14:17], v[70:73], v[118:121], v[14:17]
    ds_read_b128 v[102:105], v1 offset:50176
    v_mfma_f32_16x16x32_bf16 v[18:21], v[74:77], v[114:117], v[18:21]
    ds_read_b128 v[106:109], v243 offset:7168
    v_mfma_f32_16x16x32_bf16 v[22:25], v[78:81], v[114:117], v[22:25]
    ds_read_b128 v[110:113], v243 offset:21504
    v_mfma_f32_16x16x32_bf16 v[26:29], v[74:77], v[118:121], v[26:29]
    buffer_load_dwordx4 v[146:149], v1, s[4:7], s80 offen offset:2048 sc1
    v_mfma_f32_16x16x32_bf16 v[30:33], v[78:81], v[118:121], v[30:33]
    s_mov_b64 exec, s[30:31]
    buffer_load_dword v246, v247, s[4:7], 0 offen offset:0 sc1
    s_mov_b64 exec, -1
    v_mfma_f32_16x16x32_bf16 v[34:37], v[114:117], v[82:85], v[34:37]
    v_mfma_f32_16x16x32_bf16 v[38:41], v[114:117], v[86:89], v[38:41]
    buffer_load_dwordx4 v[150:153], v1, s[4:7], s84 offen offset:2048 sc1
    v_mfma_f32_16x16x32_bf16 v[42:45], v[118:121], v[82:85], v[42:45]
    v_mfma_f32_16x16x32_bf16 v[46:49], v[118:121], v[86:89], v[46:49]
    s_waitcnt vmcnt(12)
    s_waitcnt lgkmcnt(0)
    v_mfma_f32_16x16x32_bf16 v[2:5], v[90:93], v[122:125], v[2:5]
    ds_read_b128 v[66:69], v1 offset:8192
    v_mfma_f32_16x16x32_bf16 v[6:9], v[94:97], v[122:125], v[6:9]
    ds_read_b128 v[70:73], v1 offset:22528
    v_mfma_f32_16x16x32_bf16 v[10:13], v[90:93], v[126:129], v[10:13]
    ds_read_b128 v[74:77], v1 offset:36864
    v_mfma_f32_16x16x32_bf16 v[14:17], v[94:97], v[126:129], v[14:17]
    ds_read_b128 v[78:81], v1 offset:51200
    v_mfma_f32_16x16x32_bf16 v[18:21], v[98:101], v[122:125], v[18:21]
    ds_read_b128 v[82:85], v243 offset:8192
    v_mfma_f32_16x16x32_bf16 v[22:25], v[102:105], v[122:125], v[22:25]
    ds_read_b128 v[86:89], v243 offset:22528
    v_mfma_f32_16x16x32_bf16 v[26:29], v[98:101], v[126:129], v[26:29]
    buffer_load_dwordx4 v[154:157], v1, s[4:7], s80 offen offset:3072 sc1
    v_mfma_f32_16x16x32_bf16 v[30:33], v[102:105], v[126:129], v[30:33]
    v_mfma_f32_16x16x32_bf16 v[34:37], v[122:125], v[106:109], v[34:37]
    v_mfma_f32_16x16x32_bf16 v[38:41], v[122:125], v[110:113], v[38:41]
    buffer_load_dwordx4 v[158:161], v1, s[4:7], s84 offen offset:3072 sc1
    v_mfma_f32_16x16x32_bf16 v[42:45], v[126:129], v[106:109], v[42:45]
    v_mfma_f32_16x16x32_bf16 v[46:49], v[126:129], v[110:113], v[46:49]
    s_waitcnt vmcnt(5)
    s_waitcnt lgkmcnt(0)
    v_mfma_f32_16x16x32_bf16 v[2:5], v[66:69], v[130:133], v[2:5]
    ds_read_b128 v[90:93], v1 offset:9216
    v_mfma_f32_16x16x32_bf16 v[6:9], v[70:73], v[130:133], v[6:9]
    ds_read_b128 v[94:97], v1 offset:23552
    v_add_f32 v218, v218, v220
    v_add_f32 v222, v222, v224
    v_mfma_f32_16x16x32_bf16 v[10:13], v[66:69], v[134:137], v[10:13]
    ds_read_b128 v[98:101], v1 offset:37888
    v_add_f32 v218, v218, v222
    v_add_f32 v219, v219, v221
    v_mfma_f32_16x16x32_bf16 v[14:17], v[70:73], v[134:137], v[14:17]
    ds_read_b128 v[102:105], v1 offset:52224
    v_add_f32 v223, v223, v225
    v_add_f32 v219, v219, v223
    v_mfma_f32_16x16x32_bf16 v[18:21], v[74:77], v[130:133], v[18:21]
    ds_read_b128 v[106:109], v243 offset:9216
    v_mov_b32 v220, v218
    s_nop 1
    v_permlane32_swap_b32 v218, v220
    v_mfma_f32_16x16x32_bf16 v[22:25], v[78:81], v[130:133], v[22:25]
    ds_read_b128 v[110:113], v243 offset:23552
    v_add_f32 v218, v218, v220
    v_mov_b32 v220, v218
    v_mfma_f32_16x16x32_bf16 v[26:29], v[74:77], v[134:137], v[26:29]
    buffer_load_dwordx4 v[114:117], v1, s[4:7], s81 offen offset:0 sc1
    v_permlane16_swap_b32 v218, v220
    v_add_f32 v218, v218, v220
    v_mfma_f32_16x16x32_bf16 v[30:33], v[78:81], v[134:137], v[30:33]
    v_mov_b32 v221, v219
    s_nop 1
    v_permlane32_swap_b32 v219, v221
    v_mfma_f32_16x16x32_bf16 v[34:37], v[130:133], v[82:85], v[34:37]
    v_add_f32 v219, v219, v221
    v_mov_b32 v221, v219
    v_mfma_f32_16x16x32_bf16 v[38:41], v[130:133], v[86:89], v[38:41]
    buffer_load_dwordx4 v[118:121], v1, s[4:7], s85 offen offset:0 sc1
    v_permlane16_swap_b32 v219, v221
    v_add_f32 v219, v219, v221
    v_mfma_f32_16x16x32_bf16 v[42:45], v[134:137], v[82:85], v[42:45]
    v_mfma_f32_16x16x32_bf16 v[46:49], v[134:137], v[86:89], v[46:49]
    s_waitcnt vmcnt(8)
    s_waitcnt vmcnt(5)
    s_mov_b64 exec, s[30:31]
    v_cmp_ne_u32 vcc, s47, v246
    s_mov_b64 exec, -1
    s_nop 2
    s_cbranch_vccz L_early_3
    s_mov_b64 s[94:95], s[30:31]
    s_mov_b64 exec, s[94:95]
    s_mov_b32 s49, 0
L_poll_4:
    buffer_load_dword v253, v247, s[4:7], 0 offen sc1
    s_waitcnt vmcnt(0)
    v_cmp_ne_u32 vcc, s47, v253
    s_nop 4
    s_cbranch_vccz L_polldone_5
    s_add_u32 s49, s49, 1
    s_cmp_lt_u32 s49, 200000
    s_cbranch_scc1 L_poll_4
    s_add_u32 s99, s99, 1
L_polldone_5:
    s_mov_b64 exec, -1
L_early_3:
    s_nop 0
    s_waitcnt lgkmcnt(0)
    v_mfma_f32_16x16x32_bf16 v[2:5], v[90:93], v[138:141], v[2:5]
    ds_read_b128 v[66:69], v1 offset:10240
    v_mfma_f32_16x16x32_bf16 v[6:9], v[94:97], v[138:141], v[6:9]
    ds_read_b128 v[70:73], v1 offset:24576
    v_mul_f32 v218, 0x3b124925, v218
    v_mul_f32 v219, 0x3b124925, v219
    v_mfma_f32_16x16x32_bf16 v[10:13], v[90:93], v[142:145], v[10:13]
    ds_read_b128 v[74:77], v1 offset:38912
    v_fma_f32 v219, -v218, v218, v219
    v_max_f32 v219, 0, v219
    v_mfma_f32_16x16x32_bf16 v[14:17], v[94:97], v[142:145], v[14:17]
    ds_read_b128 v[78:81], v1 offset:53248
    buffer_load_dwordx2 v[210:211], v240, s[4:7], s86 offen offset:0 sc1
    v_add_f32 v220, 0x3727c5ac, v219
    v_rsq_f32 v220, v220
    v_mfma_f32_16x16x32_bf16 v[18:21], v[98:101], v[138:141], v[18:21]
    ds_read_b128 v[82:85], v243 offset:10240
    v_mov_b32 v219, v220
    v_mov_b32 v235, v218
    v_mfma_f32_16x16x32_bf16 v[22:25], v[102:105], v[138:141], v[22:25]
    ds_read_b128 v[86:89], v243 offset:24576
    buffer_load_dwordx2 v[212:213], v240, s[4:7], s86 offen offset:512 sc1
    v_mov_b32 v238, v219
    v_add_f32 v226, v226, v228
    v_mfma_f32_16x16x32_bf16 v[26:29], v[98:101], v[142:145], v[26:29]
    buffer_load_dwordx4 v[122:125], v1, s[4:7], s81 offen offset:1024 sc1
    v_add_f32 v230, v230, v232
    v_add_f32 v226, v226, v230
    v_mfma_f32_16x16x32_bf16 v[30:33], v[102:105], v[142:145], v[30:33]
    v_add_f32 v227, v227, v229
    v_add_f32 v231, v231, v233
    v_mfma_f32_16x16x32_bf16 v[34:37], v[138:141], v[106:109], v[34:37]
    v_add_f32 v227, v227, v231
    v_mov_b32 v228, v226
    v_mfma_f32_16x16x32_bf16 v[38:41], v[138:141], v[110:113], v[38:41]
    buffer_load_dwordx4 v[126:129], v1, s[4:7], s85 offen offset:1024 sc1
    v_permlane32_swap_b32 v226, v228
    v_add_f32 v226, v226, v228
    v_mfma_f32_16x16x32_bf16 v[42:45], v[142:145], v[106:109], v[42:45]
    s_mov_b32 m0, s75
    s_nop 0
    buffer_load_dwordx4 v1, s[4:7], s74 offen offset:0 sc1 lds
    buffer_load_dwordx4 v1, s[4:7], s74 offen offset:1024 sc1 lds
    v_mfma_f32_16x16x32_bf16 v[46:49], v[142:145], v[110:113], v[46:49]
    buffer_load_dwordx4 v1, s[4:7], s74 offen offset:2048 sc1 lds
    buffer_load_dwordx4 v1, s[4:7], s74 offen offset:3072 sc1 lds
    s_waitcnt vmcnt(12)
    s_waitcnt lgkmcnt(0)
    v_mfma_f32_16x16x32_bf16 v[2:5], v[66:69], v[146:149], v[2:5]
    ds_read_b128 v[90:93], v1 offset:11264
    v_mfma_f32_16x16x32_bf16 v[6:9], v[70:73], v[146:149], v[6:9]
    ds_read_b128 v[94:97], v1 offset:25600
    v_mov_b32 v228, v226
    s_nop 1
    v_permlane16_swap_b32 v226, v228
    v_mfma_f32_16x16x32_bf16 v[10:13], v[66:69], v[150:153], v[10:13]
    ds_read_b128 v[98:101], v1 offset:39936
    v_add_f32 v226, v226, v228
    v_mov_b32 v229, v227
    v_mfma_f32_16x16x32_bf16 v[14:17], v[70:73], v[150:153], v[14:17]
    ds_read_b128 v[102:105], v1 offset:54272
    v_permlane32_swap_b32 v227, v229
    v_add_f32 v227, v227, v229
    v_mfma_f32_16x16x32_bf16 v[18:21], v[74:77], v[146:149], v[18:21]
    ds_read_b128 v[106:109], v243 offset:11264
    v_mov_b32 v229, v227
    s_nop 1
    v_permlane16_swap_b32 v227, v229
    v_mfma_f32_16x16x32_bf16 v[22:25], v[78:81], v[146:149], v[22:25]
    ds_read_b128 v[110:113], v243 offset:25600
    v_add_f32 v227, v227, v229
    v_mul_f32 v226, 0x3b124925, v226
    v_mfma_f32_16x16x32_bf16 v[26:29], v[74:77], v[150:153], v[26:29]
    v_mul_f32 v227, 0x3b124925, v227
    v_fma_f32 v227, -v226, v226, v227
    v_mfma_f32_16x16x32_bf16 v[30:33], v[78:81], v[150:153], v[30:33]
    v_max_f32 v227, 0, v227
    v_add_f32 v228, 0x3727c5ac, v227
    v_mfma_f32_16x16x32_bf16 v[34:37], v[146:149], v[82:85], v[34:37]
    buffer_load_dwordx2 v[214:215], v240, s[4:7], s86 offen offset:1024 sc1
    v_rsq_f32 v228, v228
    s_nop 0
    v_mov_b32 v227, v228
    v_mfma_f32_16x16x32_bf16 v[38:41], v[146:149], v[86:89], v[38:41]
    v_mov_b32 v236, v226
    v_mov_b32 v239, v227
    v_mfma_f32_16x16x32_bf16 v[42:45], v[150:153], v[82:85], v[42:45]
    v_mfma_f32_16x16x32_bf16 v[46:49], v[150:153], v[86:89], v[46:49]
    buffer_load_dwordx2 v[216:217], v241, s[4:7], s86 offen offset:1536 sc1
    s_waitcnt vmcnt(12)
    s_waitcnt lgkmcnt(0)
    v_mfma_f32_16x16x32_bf16 v[2:5], v[90:93], v[154:157], v[2:5]
    ds_read_b128 v[66:69], v1 offset:12288
    v_mfma_f32_16x16x32_bf16 v[6:9], v[94:97], v[154:157], v[6:9]
    ds_read_b128 v[70:73], v1 offset:26624
    v_mfma_f32_16x16x32_bf16 v[10:13], v[90:93], v[158:161], v[10:13]
    ds_read_b128 v[74:77], v1 offset:40960
    v_mfma_f32_16x16x32_bf16 v[14:17], v[94:97], v[158:161], v[14:17]
    ds_read_b128 v[78:81], v1 offset:55296
    v_mfma_f32_16x16x32_bf16 v[18:21], v[98:101], v[154:157], v[18:21]
    ds_read_b128 v[82:85], v243 offset:12288
    v_mfma_f32_16x16x32_bf16 v[22:25], v[102:105], v[154:157], v[22:25]
    ds_read_b128 v[86:89], v243 offset:26624
    v_mfma_f32_16x16x32_bf16 v[26:29], v[98:101], v[158:161], v[26:29]
    v_mfma_f32_16x16x32_bf16 v[30:33], v[102:105], v[158:161], v[30:33]
    v_mfma_f32_16x16x32_bf16 v[34:37], v[154:157], v[106:109], v[34:37]
    v_mfma_f32_16x16x32_bf16 v[38:41], v[154:157], v[110:113], v[38:41]
    v_mfma_f32_16x16x32_bf16 v[42:45], v[158:161], v[106:109], v[42:45]
    v_mfma_f32_16x16x32_bf16 v[46:49], v[158:161], v[110:113], v[46:49]
    s_waitcnt vmcnt(10)
    s_mov_b32 s30, -1
    s_mov_b32 s31, 0x3fffffff
    s_waitcnt lgkmcnt(0)
    v_mfma_f32_16x16x32_bf16 v[2:5], v[66:69], v[114:117], v[2:5]
    ds_read_b128 v[90:93], v1 offset:13312
    v_mfma_f32_16x16x32_bf16 v[6:9], v[70:73], v[114:117], v[6:9]
    ds_read_b128 v[94:97], v1 offset:27648
    v_mfma_f32_16x16x32_bf16 v[10:13], v[66:69], v[118:121], v[10:13]
    ds_read_b128 v[98:101], v1 offset:41984
    v_mfma_f32_16x16x32_bf16 v[14:17], v[70:73], v[118:121], v[14:17]
    ds_read_b128 v[102:105], v1 offset:56320
    v_mfma_f32_16x16x32_bf16 v[18:21], v[74:77], v[114:117], v[18:21]
    ds_read_b128 v[106:109], v243 offset:13312
    v_mfma_f32_16x16x32_bf16 v[22:25], v[78:81], v[114:117], v[22:25]
    ds_read_b128 v[110:113], v243 offset:27648
    v_mfma_f32_16x16x32_bf16 v[26:29], v[74:77], v[118:121], v[26:29]
    v_mfma_f32_16x16x32_bf16 v[30:33], v[78:81], v[118:121], v[30:33]
    v_mfma_f32_16x16x32_bf16 v[34:37], v[114:117], v[82:85], v[34:37]
    v_mfma_f32_16x16x32_bf16 v[38:41], v[114:117], v[86:89], v[38:41]
    v_mfma_f32_16x16x32_bf16 v[42:45], v[118:121], v[82:85], v[42:45]
    v_mfma_f32_16x16x32_bf16 v[46:49], v[118:121], v[86:89], v[46:49]
    s_waitcnt vmcnt(0)
    s_waitcnt lgkmcnt(0)
    v_mfma_f32_16x16x32_bf16 v[2:5], v[90:93], v[122:125], v[2:5]
    ds_read_b128 v[66:69], v244 offset:0
    v_mfma_f32_16x16x32_bf16 v[6:9], v[94:97], v[122:125], v[6:9]
    ds_read_b128 v[70:73], v244 offset:64
    v_add_f32 v210, v210, v212
    v_add_f32 v214, v214, v216
    v_mfma_f32_16x16x32_bf16 v[10:13], v[90:93], v[126:129], v[10:13]
    ds_read_b128 v[74:77], v244 offset:128
    v_add_f32 v210, v210, v214
    v_add_f32 v211, v211, v213
    v_mfma_f32_16x16x32_bf16 v[14:17], v[94:97], v[126:129], v[14:17]
    ds_read_b128 v[78:81], v244 offset:192
    v_add_f32 v215, v215, v217
    v_add_f32 v211, v211, v215
    v_mfma_f32_16x16x32_bf16 v[18:21], v[98:101], v[122:125], v[18:21]
    ds_read_b32 v82, v245 offset:256
    v_mov_b32 v212, v210
    s_nop 1
    v_permlane32_swap_b32 v210, v212
    v_mfma_f32_16x16x32_bf16 v[22:25], v[102:105], v[122:125], v[22:25]
    ds_read_b32 v83, v245 offset:320
    v_add_f32 v210, v210, v212
    v_mov_b32 v212, v210
    v_mfma_f32_16x16x32_bf16 v[26:29], v[98:101], v[126:129], v[26:29]
    s_nop 0
    v_permlane16_swap_b32 v210, v212
    v_add_f32 v210, v210, v212
    v_mfma_f32_16x16x32_bf16 v[30:33], v[102:105], v[126:129], v[30:33]
    v_mov_b32 v213, v211
    s_nop 1
    v_permlane32_swap_b32 v211, v213
    v_mfma_f32_16x16x32_bf16 v[34:37], v[122:125], v[106:109], v[34:37]
    s_mov_b64 exec, s[30:31]
    buffer_load_dword v249, v248, s[4:7], 0 offen offset:0 sc1
    s_mov_b64 exec, -1
    v_add_f32 v211, v211, v213
    v_mov_b32 v213, v211
    v_mfma_f32_16x16x32_bf16 v[38:41], v[122:125], v[110:113], v[38:41]
    s_nop 0
    v_permlane16_swap_b32 v211, v213
    v_add_f32 v211, v211, v213
    v_mfma_f32_16x16x32_bf16 v[42:45], v[126:129], v[106:109], v[42:45]
    v_mul_f32 v210, 0x3b124925, v210
    v_mul_f32 v211, 0x3b124925, v211
    v_mfma_f32_16x16x32_bf16 v[46:49], v[126:129], v[110:113], v[46:49]
    v_fma_f32 v211, -v210, v210, v211
    v_max_f32 v211, 0, v211
    s_branch L_a_epi
L_c_loop1:
    v_accvgpr_read_b32 v178, a244
    v_accvgpr_read_b32 v179, a245
    v_accvgpr_read_b32 v180, a246
    v_accvgpr_read_b32 v181, a247
    v_accvgpr_read_b32 v182, a248
    v_accvgpr_read_b32 v183, a249
    v_accvgpr_read_b32 v184, a250
    v_accvgpr_read_b32 v185, a251
    ds_read_b128 v[18:21], v252 offset:0
    ds_read_b128 v[22:25], v252 offset:1024
    ds_read_b128 v[26:29], v252 offset:2048
    ds_read_b128 v[30:33], v252 offset:3072
    ds_read_b128 v[34:37], v252 offset:4096
    ds_read_b128 v[38:41], v252 offset:5120
    s_waitcnt lgkmcnt(4)
    v_mfma_f32_16x16x32_bf16 v[2:5], v[66:69], v[18:21], 0
    s_add_u32 s36, s20, 14336
    s_add_u32 m0, s21, 32768
    v_mfma_f32_16x16x32_bf16 v[6:9], v[70:73], v[18:21], 0
    ds_read_b128 v[42:45], v252 offset:6144
    v_mfma_f32_16x16x32_bf16 v[2:5], v[74:77], v[22:25], v[2:5]
    buffer_load_dwordx4 v1, s[4:7], s36 offen offset:0 sc1 lds
    v_mfma_f32_16x16x32_bf16 v[6:9], v[78:81], v[22:25], v[6:9]
    ds_read_b128 v[46:49], v252 offset:7168
    s_waitcnt lgkmcnt(4)
    v_mfma_f32_16x16x32_bf16 v[2:5], v[82:85], v[26:29], v[2:5]
    buffer_load_dwordx4 v1, s[4:7], s36 offen offset:1024 sc1 lds
    v_mfma_f32_16x16x32_bf16 v[6:9], v[86:89], v[26:29], v[6:9]
    ds_read_b128 v[18:21], v252 offset:8192
    v_mfma_f32_16x16x32_bf16 v[2:5], v[90:93], v[30:33], v[2:5]
    buffer_load_dwordx4 v1, s[4:7], s36 offen offset:2048 sc1 lds
    v_mfma_f32_16x16x32_bf16 v[6:9], v[94:97], v[30:33], v[6:9]
    ds_read_b128 v[22:25], v252 offset:9216
    s_waitcnt lgkmcnt(4)
    s_waitcnt vmcnt(7)
    v_mfma_f32_16x16x32_bf16 v[2:5], v[98:101], v[34:37], v[2:5]
    buffer_load_dwordx4 v1, s[4:7], s36 offen offset:3072 sc1 lds
    v_add_f32 v198, v198, v200
    v_add_f32 v202, v202, v204
    v_add_f32 v198, v198, v202
    v_add_f32 v199, v199, v201
    v_mfma_f32_16x16x32_bf16 v[6:9], v[102:105], v[34:37], v[6:9]
    ds_read_b128 v[26:29], v252 offset:10240
    v_add_f32 v203, v203, v205
    v_add_f32 v199, v199, v203
    v_mov_b32 v200, v198
    v_mfma_f32_16x16x32_bf16 v[2:5], v[106:109], v[38:41], v[2:5]
    s_nop 0
    v_permlane32_swap_b32 v198, v200
    v_add_f32 v198, v198, v200
    v_mov_b32 v200, v198
    v_mfma_f32_16x16x32_bf16 v[6:9], v[110:113], v[38:41], v[6:9]
    ds_read_b128 v[30:33], v252 offset:11264
    s_waitcnt lgkmcnt(4)
    v_permlane16_swap_b32 v198, v200
    v_add_f32 v198, v198, v200
    v_mov_b32 v201, v199
    s_nop 1
    v_permlane32_swap_b32 v199, v201
    v_mfma_f32_16x16x32_bf16 v[2:5], v[114:117], v[42:45], v[2:5]
    v_add_f32 v199, v199, v201
    v_mov_b32 v201, v199
    s_nop 1
    v_permlane16_swap_b32 v199, v201
    v_mfma_f32_16x16x32_bf16 v[6:9], v[118:121], v[42:45], v[6:9]
    ds_read_b128 v[34:37], v252 offset:12288
    v_add_f32 v199, v199, v201
    v_mul_f32 v198, 0x3b124925, v198
    v_mul_f32 v199, 0x3b124925, v199
    v_mfma_f32_16x16x32_bf16 v[2:5], v[122:125], v[46:49], v[2:5]
    s_waitcnt vmcnt(4)
    s_barrier
    v_fma_f32 v199, -v198, v198, v199
    v_max_f32 v199, 0, v199
    v_add_f32 v200, 0x3727c5ac, v199
    v_rsq_f32 v200, v200
    v_mfma_f32_16x16x32_bf16 v[6:9], v[126:129], v[46:49], v[6:9]
    ds_read_b128 v[38:41], v252 offset:13312
    s_waitcnt lgkmcnt(4)
    v_mul_f32 v199, v199, v200
    v_fmaak_f32 v199, v199, v200, 0x3727c5ac
    v_rsq_f32 v199, v199
    v_mfma_f32_16x16x32_bf16 v[2:5], v[130:133], v[18:21], v[2:5]
    v_mul_f32 v199, v199, v200
    v_add_f32 v206, v206, v208
    v_add_f32 v210, v210, v212
    v_mfma_f32_16x16x32_bf16 v[6:9], v[134:137], v[18:21], v[6:9]
    ds_read_b128 v[42:45], v252 offset:16384
    v_add_f32 v206, v206, v210
    v_add_f32 v207, v207, v209
    v_add_f32 v211, v211, v213
    v_mfma_f32_16x16x32_bf16 v[2:5], v[138:141], v[22:25], v[2:5]
    v_add_f32 v207, v207, v211
    v_mov_b32 v208, v206
    s_nop 1
    v_permlane32_swap_b32 v206, v208
    v_add_f32 v206, v206, v208
    v_mfma_f32_16x16x32_bf16 v[6:9], v[142:145], v[22:25], v[6:9]
    ds_read_b128 v[46:49], v252 offset:17408
    s_waitcnt lgkmcnt(4)
    v_mov_b32 v208, v206
    s_nop 1
    v_permlane16_swap_b32 v206, v208
    v_add_f32 v206, v206, v208
    v_mfma_f32_16x16x32_bf16 v[2:5], v[146:149], v[26:29], v[2:5]
    v_mov_b32 v209, v207
    s_nop 1
    v_permlane32_swap_b32 v207, v209
    v_add_f32 v207, v207, v209
    v_mfma_f32_16x16x32_bf16 v[6:9], v[150:153], v[26:29], v[6:9]
    ds_read_b128 v[18:21], v252 offset:18432
    v_mov_b32 v209, v207
    s_nop 1
    v_permlane16_swap_b32 v207, v209
    v_add_f32 v207, v207, v209
    v_mul_f32 v206, 0x3b124925, v206
    v_mfma_f32_16x16x32_bf16 v[2:5], v[154:157], v[30:33], v[2:5]
    v_mul_f32 v207, 0x3b124925, v207
    v_fma_f32 v207, -v206, v206, v207
    v_max_f32 v207, 0, v207
    v_mfma_f32_16x16x32_bf16 v[6:9], v[158:161], v[30:33], v[6:9]
    ds_read_b128 v[22:25], v252 offset:19456
    s_waitcnt lgkmcnt(4)
    v_add_f32 v208, 0x3727c5ac, v207
    v_rsq_f32 v208, v208
    s_nop 0
    v_mul_f32 v207, v207, v208
    v_mfma_f32_16x16x32_bf16 v[2:5], v[162:165], v[34:37], v[2:5]
    v_fmaak_f32 v207, v207, v208, 0x3727c5ac
    v_rsq_f32 v207, v207
    s_nop 0
    v_mul_f32 v207, v207, v208
    ds_write_b64 v247, v[198:199]
    v_mfma_f32_16x16x32_bf16 v[6:9], v[166:169], v[34:37], v[6:9]
    ds_read_b128 v[26:29], v252 offset:20480
    ds_write_b64 v247, v[206:207] offset:512
    v_lshlrev_b32 v186, 16, v194
    v_and_b32 v187, 0xffff0000, v194
    v_mfma_f32_16x16x32_bf16 v[2:5], v[170:173], v[38:41], v[2:5]
    v_lshlrev_b32 v188, 16, v195
    v_and_b32 v189, 0xffff0000, v195
    v_lshlrev_b32 v190, 16, v196
    v_mfma_f32_16x16x32_bf16 v[6:9], v[174:177], v[38:41], v[6:9]
    ds_read_b128 v[30:33], v252 offset:21504
    s_waitcnt lgkmcnt(4)
    v_and_b32 v191, 0xffff0000, v196
    v_lshlrev_b32 v192, 16, v197
    v_and_b32 v193, 0xffff0000, v197
    s_waitcnt lgkmcnt(0)
    s_barrier
    ds_read_b64 v[214:215], v246 offset:0
    s_waitcnt lgkmcnt(0)
    v_pk_fma_f32 v[2:3], v[178:179], v[214:215], v[2:3] op_sel_hi:[1,0,1] neg_lo:[0,1,0] neg_hi:[0,1,0]
    v_pk_fma_f32 v[4:5], v[180:181], v[214:215], v[4:5] op_sel_hi:[1,0,1] neg_lo:[0,1,0] neg_hi:[0,1,0]
    v_pk_fma_f32 v[6:7], v[182:183], v[214:215], v[6:7] op_sel_hi:[1,0,1] neg_lo:[0,1,0] neg_hi:[0,1,0]
    v_pk_fma_f32 v[8:9], v[184:185], v[214:215], v[8:9] op_sel_hi:[1,0,1] neg_lo:[0,1,0] neg_hi:[0,1,0]
    v_pk_fma_f32 v[2:3], v[2:3], v[214:215], v[186:187] op_sel:[0,1,0] op_sel_hi:[1,1,1]
    v_pk_fma_f32 v[4:5], v[4:5], v[214:215], v[188:189] op_sel:[0,1,0] op_sel_hi:[1,1,1]
    v_pk_fma_f32 v[6:7], v[6:7], v[214:215], v[190:191] op_sel:[0,1,0] op_sel_hi:[1,1,1]
    v_pk_fma_f32 v[8:9], v[8:9], v[214:215], v[192:193] op_sel:[0,1,0] op_sel_hi:[1,1,1]
    v_pk_mul_f32 v[50:51], v[2:3], v[2:3]
    v_pk_mul_f32 v[52:53], v[4:5], v[4:5]
    v_pk_mul_f32 v[54:55], v[6:7], v[6:7]
    v_pk_mul_f32 v[56:57], v[8:9], v[8:9]
    v_pk_fma_f32 v[50:51], v[50:51], s[34:35], v[218:219]
    v_pk_fma_f32 v[52:53], v[52:53], s[34:35], v[218:219]
    v_pk_fma_f32 v[54:55], v[54:55], s[34:35], v[218:219]
    v_pk_fma_f32 v[56:57], v[56:57], s[34:35], v[218:219]
    v_pk_mul_f32 v[50:51], v[50:51], v[2:3]
    v_pk_mul_f32 v[52:53], v[52:53], v[4:5]
    v_pk_mul_f32 v[54:55], v[54:55], v[6:7]
    v_pk_mul_f32 v[56:57], v[56:57], v[8:9]
    v_mfma_f32_16x16x32_bf16 v[10:13], v[66:69], v[42:45], 0
    s_add_u32 s36, s20, 71680
    s_add_u32 m0, s21, 49152
    s_add_u32 s22, s25, 12288
    v_exp_f32 v50, v50
    v_mfma_f32_16x16x32_bf16 v[14:17], v[70:73], v[42:45], 0
    ds_read_b128 v[34:37], v252 offset:22528
    v_mfma_f32_16x16x32_bf16 v[10:13], v[74:77], v[46:49], v[10:13]
    buffer_load_dwordx4 v1, s[4:7], s36 offen offset:0 sc1 lds
    v_exp_f32 v51, v51
    v_mfma_f32_16x16x32_bf16 v[14:17], v[78:81], v[46:49], v[14:17]
    ds_read_b128 v[38:41], v252 offset:23552
    s_waitcnt lgkmcnt(4)
    v_add_f32 v50, 1.0, v50
    v_mfma_f32_16x16x32_bf16 v[10:13], v[82:85], v[18:21], v[10:13]
    buffer_load_dwordx4 v1, s[4:7], s36 offen offset:1024 sc1 lds
    v_exp_f32 v52, v52
    v_mfma_f32_16x16x32_bf16 v[14:17], v[86:89], v[18:21], v[14:17]
    ds_read_b128 v[42:45], v252 offset:24576
    v_add_f32 v51, 1.0, v51
    v_mfma_f32_16x16x32_bf16 v[10:13], v[90:93], v[22:25], v[10:13]
    buffer_load_dwordx4 v1, s[4:7], s36 offen offset:2048 sc1 lds
    v_exp_f32 v53, v53
    v_mfma_f32_16x16x32_bf16 v[14:17], v[94:97], v[22:25], v[14:17]
    ds_read_b128 v[46:49], v252 offset:25600
    s_waitcnt lgkmcnt(4)
    v_add_f32 v52, 1.0, v52
    v_mfma_f32_16x16x32_bf16 v[10:13], v[98:101], v[26:29], v[10:13]
    buffer_load_dwordx4 v1, s[4:7], s36 offen offset:3072 sc1 lds
    v_exp_f32 v54, v54
    v_mfma_f32_16x16x32_bf16 v[14:17], v[102:105], v[26:29], v[14:17]
    ds_read_b128 v[18:21], v252 offset:26624
    v_add_f32 v53, 1.0, v53
    v_mfma_f32_16x16x32_bf16 v[10:13], v[106:109], v[30:33], v[10:13]
    v_exp_f32 v55, v55
    v_mfma_f32_16x16x32_bf16 v[14:17], v[110:113], v[30:33], v[14:17]
    ds_read_b128 v[22:25], v252 offset:27648
    s_waitcnt lgkmcnt(4)
    v_add_f32 v54, 1.0, v54
    v_mfma_f32_16x16x32_bf16 v[10:13], v[114:117], v[34:37], v[10:13]
    v_exp_f32 v56, v56
    v_mfma_f32_16x16x32_bf16 v[14:17], v[118:121], v[34:37], v[14:17]
    ds_read_b128 v[26:29], v252 offset:28672
    v_add_f32 v55, 1.0, v55
    v_mfma_f32_16x16x32_bf16 v[10:13], v[122:125], v[38:41], v[10:13]
    s_waitcnt vmcnt(4)
    s_barrier
    v_exp_f32 v57, v57
    v_mfma_f32_16x16x32_bf16 v[14:17], v[126:129], v[38:41], v[14:17]
    ds_read_b128 v[30:33], v252 offset:29696
    s_waitcnt lgkmcnt(4)
    v_add_f32 v56, 1.0, v56
    v_mfma_f32_16x16x32_bf16 v[10:13], v[130:133], v[42:45], v[10:13]
    v_rcp_f32 v50, v50
    v_mfma_f32_16x16x32_bf16 v[14:17], v[134:137], v[42:45], v[14:17]
    ds_read_b128 v[34:37], v252 offset:32768
    ds_read_b64 v[216:217], v246 offset:512
    v_add_f32 v57, 1.0, v57
    v_mfma_f32_16x16x32_bf16 v[10:13], v[138:141], v[46:49], v[10:13]
    v_rcp_f32 v51, v51
    v_mfma_f32_16x16x32_bf16 v[14:17], v[142:145], v[46:49], v[14:17]
    ds_read_b128 v[38:41], v252 offset:33792
    s_waitcnt lgkmcnt(4)
    v_mfma_f32_16x16x32_bf16 v[10:13], v[146:149], v[18:21], v[10:13]
    v_rcp_f32 v52, v52
    v_mfma_f32_16x16x32_bf16 v[14:17], v[150:153], v[18:21], v[14:17]
    ds_read_b128 v[42:45], v252 offset:34816
    v_mfma_f32_16x16x32_bf16 v[10:13], v[154:157], v[22:25], v[10:13]
    v_rcp_f32 v53, v53
    v_mfma_f32_16x16x32_bf16 v[14:17], v[158:161], v[22:25], v[14:17]
    ds_read_b128 v[46:49], v252 offset:35840
    s_waitcnt lgkmcnt(4)
    v_mfma_f32_16x16x32_bf16 v[10:13], v[162:165], v[26:29], v[10:13]
    v_rcp_f32 v54, v54
    v_mfma_f32_16x16x32_bf16 v[14:17], v[166:169], v[26:29], v[14:17]
    ds_read_b128 v[18:21], v252 offset:36864
    v_rcp_f32 v56, v56
    v_mfma_f32_16x16x32_bf16 v[10:13], v[170:173], v[30:33], v[10:13]
    v_rcp_f32 v55, v55
    v_mfma_f32_16x16x32_bf16 v[14:17], v[174:177], v[30:33], v[14:17]
    ds_read_b128 v[22:25], v252 offset:37888
    s_waitcnt lgkmcnt(4)
    v_rcp_f32 v57, v57
    v_pk_mul_f32 v[50:51], v[50:51], v[2:3]
    v_pk_mul_f32 v[52:53], v[52:53], v[4:5]
    v_pk_mul_f32 v[54:55], v[54:55], v[6:7]
    v_pk_mul_f32 v[56:57], v[56:57], v[8:9]
    v_cvt_pk_bf16_f32 v58, v50, v51
    v_cvt_pk_bf16_f32 v59, v52, v53
    v_cvt_pk_bf16_f32 v60, v54, v55
    v_cvt_pk_bf16_f32 v61, v56, v57
    s_add_u32 s24, s32, 0
    buffer_store_dwordx4 v[58:61], v1, s[4:7], s24 offen sc1
    v_pk_fma_f32 v[10:11], v[178:179], v[216:217], v[10:11] op_sel_hi:[1,0,1] neg_lo:[0,1,0] neg_hi:[0,1,0]
    v_pk_fma_f32 v[12:13], v[180:181], v[216:217], v[12:13] op_sel_hi:[1,0,1] neg_lo:[0,1,0] neg_hi:[0,1,0]
    v_pk_fma_f32 v[14:15], v[182:183], v[216:217], v[14:15] op_sel_hi:[1,0,1] neg_lo:[0,1,0] neg_hi:[0,1,0]
    v_pk_fma_f32 v[16:17], v[184:185], v[216:217], v[16:17] op_sel_hi:[1,0,1] neg_lo:[0,1,0] neg_hi:[0,1,0]
    v_pk_fma_f32 v[10:11], v[10:11], v[216:217], v[186:187] op_sel:[0,1,0] op_sel_hi:[1,1,1]
    v_pk_fma_f32 v[12:13], v[12:13], v[216:217], v[188:189] op_sel:[0,1,0] op_sel_hi:[1,1,1]
    v_pk_fma_f32 v[14:15], v[14:15], v[216:217], v[190:191] op_sel:[0,1,0] op_sel_hi:[1,1,1]
    v_pk_fma_f32 v[16:17], v[16:17], v[216:217], v[192:193] op_sel:[0,1,0] op_sel_hi:[1,1,1]
    v_pk_mul_f32 v[50:51], v[10:11], v[10:11]
    v_pk_mul_f32 v[52:53], v[12:13], v[12:13]
    v_pk_mul_f32 v[54:55], v[14:15], v[14:15]
    v_pk_mul_f32 v[56:57], v[16:17], v[16:17]
    v_pk_fma_f32 v[50:51], v[50:51], s[34:35], v[218:219]
    v_pk_fma_f32 v[52:53], v[52:53], s[34:35], v[218:219]
    v_pk_fma_f32 v[54:55], v[54:55], s[34:35], v[218:219]
    v_pk_fma_f32 v[56:57], v[56:57], s[34:35], v[218:219]
    v_pk_mul_f32 v[50:51], v[50:51], v[10:11]
    v_pk_mul_f32 v[52:53], v[52:53], v[12:13]
    v_pk_mul_f32 v[54:55], v[54:55], v[14:15]
    v_pk_mul_f32 v[56:57], v[56:57], v[16:17]
    v_mfma_f32_16x16x32_bf16 v[2:5], v[66:69], v[34:37], 0
    s_add_u32 s36, s20, 28672
    s_add_u32 m0, s21, 0
    v_exp_f32 v50, v50
    v_mfma_f32_16x16x32_bf16 v[6:9], v[70:73], v[34:37], 0
    ds_read_b128 v[26:29], v252 offset:38912
    v_mfma_f32_16x16x32_bf16 v[2:5], v[74:77], v[38:41], v[2:5]
    buffer_load_dwordx4 v1, s[4:7], s36 offen offset:0 sc1 lds
    v_exp_f32 v51, v51
    v_mfma_f32_16x16x32_bf16 v[6:9], v[78:81], v[38:41], v[6:9]
    ds_read_b128 v[30:33], v252 offset:39936
    s_waitcnt lgkmcnt(4)
    v_add_f32 v50, 1.0, v50
    v_mfma_f32_16x16x32_bf16 v[2:5], v[82:85], v[42:45], v[2:5]
    buffer_load_dwordx4 v1, s[4:7], s36 offen offset:1024 sc1 lds
    v_exp_f32 v52, v52
    v_mfma_f32_16x16x32_bf16 v[6:9], v[86:89], v[42:45], v[6:9]
    ds_read_b128 v[34:37], v252 offset:40960
    v_add_f32 v51, 1.0, v51
    v_mfma_f32_16x16x32_bf16 v[2:5], v[90:93], v[46:49], v[2:5]
    buffer_load_dwordx4 v1, s[4:7], s36 offen offset:2048 sc1 lds
    v_exp_f32 v53, v53
    v_mfma_f32_16x16x32_bf16 v[6:9], v[94:97], v[46:49], v[6:9]
    ds_read_b128 v[38:41], v252 offset:41984
    s_waitcnt lgkmcnt(4)
    v_add_f32 v52, 1.0, v52
    v_mfma_f32_16x16x32_bf16 v[2:5], v[98:101], v[18:21], v[2:5]
    buffer_load_dwordx4 v1, s[4:7], s36 offen offset:3072 sc1 lds
    v_exp_f32 v54, v54
    v_mfma_f32_16x16x32_bf16 v[6:9], v[102:105], v[18:21], v[6:9]
    ds_read_b128 v[42:45], v252 offset:43008
    v_add_f32 v53, 1.0, v53
    v_mfma_f32_16x16x32_bf16 v[2:5], v[106:109], v[22:25], v[2:5]
    v_exp_f32 v55, v55
    v_mfma_f32_16x16x32_bf16 v[6:9], v[110:113], v[22:25], v[6:9]
    ds_read_b128 v[46:49], v252 offset:44032
    s_waitcnt lgkmcnt(4)
    v_add_f32 v54, 1.0, v54
    v_mfma_f32_16x16x32_bf16 v[2:5], v[114:117], v[26:29], v[2:5]
    v_exp_f32 v56, v56
    v_mfma_f32_16x16x32_bf16 v[6:9], v[118:121], v[26:29], v[6:9]
    ds_read_b128 v[18:21], v252 offset:45056
    v_add_f32 v55, 1.0, v55
    v_mfma_f32_16x16x32_bf16 v[2:5], v[122:125], v[30:33], v[2:5]
    s_waitcnt vmcnt(5)
    s_barrier
    v_exp_f32 v57, v57
    v_mfma_f32_16x16x32_bf16 v[6:9], v[126:129], v[30:33], v[6:9]
    ds_read_b128 v[22:25], v252 offset:46080
    s_waitcnt lgkmcnt(4)
    v_add_f32 v56, 1.0, v56
    v_mfma_f32_16x16x32_bf16 v[2:5], v[130:133], v[34:37], v[2:5]
    v_rcp_f32 v50, v50
    v_mfma_f32_16x16x32_bf16 v[6:9], v[134:137], v[34:37], v[6:9]
    ds_read_b128 v[26:29], v252 offset:49152
    ds_read_b64 v[214:215], v246 offset:128
    v_add_f32 v57, 1.0, v57
    v_mfma_f32_16x16x32_bf16 v[2:5], v[138:141], v[38:41], v[2:5]
    v_rcp_f32 v51, v51
    v_mfma_f32_16x16x32_bf16 v[6:9], v[142:145], v[38:41], v[6:9]
    ds_read_b128 v[30:33], v252 offset:50176
    s_waitcnt lgkmcnt(4)
    v_mfma_f32_16x16x32_bf16 v[2:5], v[146:149], v[42:45], v[2:5]
    v_rcp_f32 v52, v52
    v_mfma_f32_16x16x32_bf16 v[6:9], v[150:153], v[42:45], v[6:9]
    ds_read_b128 v[34:37], v252 offset:51200
    v_mfma_f32_16x16x32_bf16 v[2:5], v[154:157], v[46:49], v[2:5]
    v_rcp_f32 v53, v53
    v_mfma_f32_16x16x32_bf16 v[6:9], v[158:161], v[46:49], v[6:9]
    ds_read_b128 v[38:41], v252 offset:52224
    s_waitcnt lgkmcnt(4)
    v_mfma_f32_16x16x32_bf16 v[2:5], v[162:165], v[18:21], v[2:5]
    v_rcp_f32 v54, v54
    v_mfma_f32_16x16x32_bf16 v[6:9], v[166:169], v[18:21], v[6:9]
    ds_read_b128 v[42:45], v252 offset:53248
    v_rcp_f32 v56, v56
    v_mfma_f32_16x16x32_bf16 v[2:5], v[170:173], v[22:25], v[2:5]
    v_rcp_f32 v55, v55
    v_mfma_f32_16x16x32_bf16 v[6:9], v[174:177], v[22:25], v[6:9]
    ds_read_b128 v[46:49], v252 offset:54272
    s_waitcnt lgkmcnt(4)
    v_rcp_f32 v57, v57
    v_pk_mul_f32 v[50:51], v[50:51], v[10:11]
    v_pk_mul_f32 v[52:53], v[52:53], v[12:13]
    v_pk_mul_f32 v[54:55], v[54:55], v[14:15]
    v_pk_mul_f32 v[56:57], v[56:57], v[16:17]
    v_cvt_pk_bf16_f32 v62, v50, v51
    v_cvt_pk_bf16_f32 v63, v52, v53
    v_cvt_pk_bf16_f32 v64, v54, v55
    v_cvt_pk_bf16_f32 v65, v56, v57
    s_add_u32 s24, s32, 229376
    buffer_store_dwordx4 v[62:65], v1, s[4:7], s24 offen sc1
    v_pk_fma_f32 v[2:3], v[178:179], v[214:215], v[2:3] op_sel_hi:[1,0,1] neg_lo:[0,1,0] neg_hi:[0,1,0]
    v_pk_fma_f32 v[4:5], v[180:181], v[214:215], v[4:5] op_sel_hi:[1,0,1] neg_lo:[0,1,0] neg_hi:[0,1,0]
    v_pk_fma_f32 v[6:7], v[182:183], v[214:215], v[6:7] op_sel_hi:[1,0,1] neg_lo:[0,1,0] neg_hi:[0,1,0]
    v_pk_fma_f32 v[8:9], v[184:185], v[214:215], v[8:9] op_sel_hi:[1,0,1] neg_lo:[0,1,0] neg_hi:[0,1,0]
    v_pk_fma_f32 v[2:3], v[2:3], v[214:215], v[186:187] op_sel:[0,1,0] op_sel_hi:[1,1,1]
    v_pk_fma_f32 v[4:5], v[4:5], v[214:215], v[188:189] op_sel:[0,1,0] op_sel_hi:[1,1,1]
    v_pk_fma_f32 v[6:7], v[6:7], v[214:215], v[190:191] op_sel:[0,1,0] op_sel_hi:[1,1,1]
    v_pk_fma_f32 v[8:9], v[8:9], v[214:215], v[192:193] op_sel:[0,1,0] op_sel_hi:[1,1,1]
    v_pk_mul_f32 v[50:51], v[2:3], v[2:3]
    v_pk_mul_f32 v[52:53], v[4:5], v[4:5]
    v_pk_mul_f32 v[54:55], v[6:7], v[6:7]
    v_pk_mul_f32 v[56:57], v[8:9], v[8:9]
    v_pk_fma_f32 v[50:51], v[50:51], s[34:35], v[218:219]
    v_pk_fma_f32 v[52:53], v[52:53], s[34:35], v[218:219]
    v_pk_fma_f32 v[54:55], v[54:55], s[34:35], v[218:219]
    v_pk_fma_f32 v[56:57], v[56:57], s[34:35], v[218:219]
    v_pk_mul_f32 v[50:51], v[50:51], v[2:3]
    v_pk_mul_f32 v[52:53], v[52:53], v[4:5]
    v_pk_mul_f32 v[54:55], v[54:55], v[6:7]
    v_pk_mul_f32 v[56:57], v[56:57], v[8:9]
    v_mfma_f32_16x16x32_bf16 v[10:13], v[66:69], v[26:29], 0
    s_add_u32 s36, s20, 86016
    s_add_u32 m0, s21, 16384
    v_exp_f32 v50, v50
    v_mfma_f32_16x16x32_bf16 v[14:17], v[70:73], v[26:29], 0
    ds_read_b128 v[18:21], v252 offset:55296
    v_mfma_f32_16x16x32_bf16 v[10:13], v[74:77], v[30:33], v[10:13]
    buffer_load_dwordx4 v1, s[4:7], s36 offen offset:0 sc1 lds
    v_exp_f32 v51, v51
    v_mfma_f32_16x16x32_bf16 v[14:17], v[78:81], v[30:33], v[14:17]
    ds_read_b128 v[22:25], v252 offset:56320
    s_waitcnt lgkmcnt(4)
    v_add_f32 v50, 1.0, v50
    v_mfma_f32_16x16x32_bf16 v[10:13], v[82:85], v[34:37], v[10:13]
    buffer_load_dwordx4 v1, s[4:7], s36 offen offset:1024 sc1 lds
    v_exp_f32 v52, v52
    v_mfma_f32_16x16x32_bf16 v[14:17], v[86:89], v[34:37], v[14:17]
    ds_read_b128 v[26:29], v252 offset:57344
    v_add_f32 v51, 1.0, v51
    v_mfma_f32_16x16x32_bf16 v[10:13], v[90:93], v[38:41], v[10:13]
    buffer_load_dwordx4 v1, s[4:7], s36 offen offset:2048 sc1 lds
    v_exp_f32 v53, v53
    v_mfma_f32_16x16x32_bf16 v[14:17], v[94:97], v[38:41], v[14:17]
    ds_read_b128 v[30:33], v252 offset:58368
    s_waitcnt lgkmcnt(4)
    v_add_f32 v52, 1.0, v52
    v_mfma_f32_16x16x32_bf16 v[10:13], v[98:101], v[42:45], v[10:13]
    buffer_load_dwordx4 v1, s[4:7], s36 offen offset:3072 sc1 lds
    v_exp_f32 v54, v54
    v_mfma_f32_16x16x32_bf16 v[14:17], v[102:105], v[42:45], v[14:17]
    ds_read_b128 v[34:37], v252 offset:59392
    v_add_f32 v53, 1.0, v53
    v_mfma_f32_16x16x32_bf16 v[10:13], v[106:109], v[46:49], v[10:13]
    v_exp_f32 v55, v55
    v_mfma_f32_16x16x32_bf16 v[14:17], v[110:113], v[46:49], v[14:17]
    ds_read_b128 v[38:41], v252 offset:60416
    s_waitcnt lgkmcnt(4)
    v_add_f32 v54, 1.0, v54
    v_mfma_f32_16x16x32_bf16 v[10:13], v[114:117], v[18:21], v[10:13]
    v_exp_f32 v56, v56
    v_mfma_f32_16x16x32_bf16 v[14:17], v[118:121], v[18:21], v[14:17]
    ds_read_b128 v[42:45], v252 offset:61440
    v_add_f32 v55, 1.0, v55
    v_mfma_f32_16x16x32_bf16 v[10:13], v[122:125], v[22:25], v[10:13]
    s_waitcnt vmcnt(5)
    s_barrier
    v_exp_f32 v57, v57
    v_mfma_f32_16x16x32_bf16 v[14:17], v[126:129], v[22:25], v[14:17]
    ds_read_b128 v[46:49], v252 offset:62464
    s_waitcnt lgkmcnt(4)
    v_add_f32 v56, 1.0, v56
    v_mfma_f32_16x16x32_bf16 v[10:13], v[130:133], v[26:29], v[10:13]
    v_rcp_f32 v50, v50
    v_mfma_f32_16x16x32_bf16 v[14:17], v[134:137], v[26:29], v[14:17]
    ds_read_b128 v[18:21], v252 offset:0
    ds_read_b64 v[216:217], v246 offset:640
    v_add_f32 v57, 1.0, v57
    v_mfma_f32_16x16x32_bf16 v[10:13], v[138:141], v[30:33], v[10:13]
    v_rcp_f32 v51, v51
    v_mfma_f32_16x16x32_bf16 v[14:17], v[142:145], v[30:33], v[14:17]
    ds_read_b128 v[22:25], v252 offset:1024
    s_waitcnt lgkmcnt(4)
    v_mfma_f32_16x16x32_bf16 v[10:13], v[146:149], v[34:37], v[10:13]
    s_waitcnt vmcnt(9)
    s_cmp_eq_u32 s101, 0
    s_cbranch_scc1 L_slow_30
    buffer_store_dword v254, v241, s[4:7], 0 offen offset:0
    s_branch L_st_31
L_slow_30:
    buffer_store_dword v254, v241, s[4:7], 0 offen offset:0 sc1
L_st_31:
    v_rcp_f32 v52, v52
    v_mfma_f32_16x16x32_bf16 v[14:17], v[150:153], v[34:37], v[14:17]
    ds_read_b128 v[26:29], v252 offset:2048
    v_mfma_f32_16x16x32_bf16 v[10:13], v[154:157], v[38:41], v[10:13]
    v_rcp_f32 v53, v53
    v_mfma_f32_16x16x32_bf16 v[14:17], v[158:161], v[38:41], v[14:17]
    ds_read_b128 v[30:33], v252 offset:3072
    s_waitcnt lgkmcnt(4)
    v_mfma_f32_16x16x32_bf16 v[10:13], v[162:165], v[42:45], v[10:13]
    v_rcp_f32 v54, v54
    v_mfma_f32_16x16x32_bf16 v[14:17], v[166:169], v[42:45], v[14:17]
    ds_read_b128 v[34:37], v252 offset:4096
    v_rcp_f32 v56, v56
    v_mfma_f32_16x16x32_bf16 v[10:13], v[170:173], v[46:49], v[10:13]
    v_rcp_f32 v55, v55
    v_mfma_f32_16x16x32_bf16 v[14:17], v[174:177], v[46:49], v[14:17]
    ds_read_b128 v[38:41], v252 offset:5120
    s_waitcnt lgkmcnt(4)
    v_rcp_f32 v57, v57
    v_pk_mul_f32 v[50:51], v[50:51], v[2:3]
    v_pk_mul_f32 v[52:53], v[52:53], v[4:5]
    v_pk_mul_f32 v[54:55], v[54:55], v[6:7]
    v_pk_mul_f32 v[56:57], v[56:57], v[8:9]
    v_cvt_pk_bf16_f32 v58, v50, v51
    v_cvt_pk_bf16_f32 v59, v52, v53
    v_cvt_pk_bf16_f32 v60, v54, v55
    v_cvt_pk_bf16_f32 v61, v56, v57
    s_add_u32 s24, s32, 57344
    buffer_store_dwordx4 v[58:61], v1, s[4:7], s24 offen sc1
    v_pk_fma_f32 v[10:11], v[178:179], v[216:217], v[10:11] op_sel_hi:[1,0,1] neg_lo:[0,1,0] neg_hi:[0,1,0]
    v_pk_fma_f32 v[12:13], v[180:181], v[216:217], v[12:13] op_sel_hi:[1,0,1] neg_lo:[0,1,0] neg_hi:[0,1,0]
    v_pk_fma_f32 v[14:15], v[182:183], v[216:217], v[14:15] op_sel_hi:[1,0,1] neg_lo:[0,1,0] neg_hi:[0,1,0]
    v_pk_fma_f32 v[16:17], v[184:185], v[216:217], v[16:17] op_sel_hi:[1,0,1] neg_lo:[0,1,0] neg_hi:[0,1,0]
    v_pk_fma_f32 v[10:11], v[10:11], v[216:217], v[186:187] op_sel:[0,1,0] op_sel_hi:[1,1,1]
    v_pk_fma_f32 v[12:13], v[12:13], v[216:217], v[188:189] op_sel:[0,1,0] op_sel_hi:[1,1,1]
    v_pk_fma_f32 v[14:15], v[14:15], v[216:217], v[190:191] op_sel:[0,1,0] op_sel_hi:[1,1,1]
    v_pk_fma_f32 v[16:17], v[16:17], v[216:217], v[192:193] op_sel:[0,1,0] op_sel_hi:[1,1,1]
    v_pk_mul_f32 v[50:51], v[10:11], v[10:11]
    v_pk_mul_f32 v[52:53], v[12:13], v[12:13]
    v_pk_mul_f32 v[54:55], v[14:15], v[14:15]
    v_pk_mul_f32 v[56:57], v[16:17], v[16:17]
    v_pk_fma_f32 v[50:51], v[50:51], s[34:35], v[218:219]
    v_pk_fma_f32 v[52:53], v[52:53], s[34:35], v[218:219]
    v_pk_fma_f32 v[54:55], v[54:55], s[34:35], v[218:219]
    v_pk_fma_f32 v[56:57], v[56:57], s[34:35], v[218:219]
    v_pk_mul_f32 v[50:51], v[50:51], v[10:11]
    v_pk_mul_f32 v[52:53], v[52:53], v[12:13]
    v_pk_mul_f32 v[54:55], v[54:55], v[14:15]
    v_pk_mul_f32 v[56:57], v[56:57], v[16:17]
    v_mfma_f32_16x16x32_bf16 v[2:5], v[66:69], v[18:21], 0
    s_add_u32 s36, s20, 43008
    s_add_u32 m0, s21, 32768
    v_exp_f32 v50, v50
    v_mfma_f32_16x16x32_bf16 v[6:9], v[70:73], v[18:21], 0
    ds_read_b128 v[42:45], v252 offset:6144
    v_mfma_f32_16x16x32_bf16 v[2:5], v[74:77], v[22:25], v[2:5]
    buffer_load_dwordx4 v1, s[4:7], s36 offen offset:0 sc1 lds
    v_exp_f32 v51, v51
    v_mfma_f32_16x16x32_bf16 v[6:9], v[78:81], v[22:25], v[6:9]
    ds_read_b128 v[46:49], v252 offset:7168
    s_waitcnt lgkmcnt(4)
    v_add_f32 v50, 1.0, v50
    v_mfma_f32_16x16x32_bf16 v[2:5], v[82:85], v[26:29], v[2:5]
    buffer_load_dwordx4 v1, s[4:7], s36 offen offset:1024 sc1 lds
    v_exp_f32 v52, v52
    v_mfma_f32_16x16x32_bf16 v[6:9], v[86:89], v[26:29], v[6:9]
    ds_read_b128 v[18:21], v252 offset:8192
    v_add_f32 v51, 1.0, v51
    v_mfma_f32_16x16x32_bf16 v[2:5], v[90:93], v[30:33], v[2:5]
    buffer_load_dwordx4 v1, s[4:7], s36 offen offset:2048 sc1 lds
    v_exp_f32 v53, v53
    v_mfma_f32_16x16x32_bf16 v[6:9], v[94:97], v[30:33], v[6:9]
    ds_read_b128 v[22:25], v252 offset:9216
    s_waitcnt lgkmcnt(4)
    v_add_f32 v52, 1.0, v52
    v_mfma_f32_16x16x32_bf16 v[2:5], v[98:101], v[34:37], v[2:5]
    buffer_load_dwordx4 v1, s[4:7], s36 offen offset:3072 sc1 lds
    v_exp_f32 v54, v54
    v_mfma_f32_16x16x32_bf16 v[6:9], v[102:105], v[34:37], v[6:9]
    ds_read_b128 v[26:29], v252 offset:10240
    v_add_f32 v53, 1.0, v53
    v_mfma_f32_16x16x32_bf16 v[2:5], v[106:109], v[38:41], v[2:5]
    v_exp_f32 v55, v55
    v_mfma_f32_16x16x32_bf16 v[6:9], v[110:113], v[38:41], v[6:9]
    ds_read_b128 v[30:33], v252 offset:11264
    s_waitcnt lgkmcnt(4)
    v_add_f32 v54, 1.0, v54
    v_mfma_f32_16x16x32_bf16 v[2:5], v[114:117], v[42:45], v[2:5]
    v_exp_f32 v56, v56
    v_mfma_f32_16x16x32_bf16 v[6:9], v[118:121], v[42:45], v[6:9]
    ds_read_b128 v[34:37], v252 offset:12288
    v_add_f32 v55, 1.0, v55
    v_mfma_f32_16x16x32_bf16 v[2:5], v[122:125], v[46:49], v[2:5]
    s_waitcnt vmcnt(6)
    s_barrier
    v_exp_f32 v57, v57
    v_mfma_f32_16x16x32_bf16 v[6:9], v[126:129], v[46:49], v[6:9]
    ds_read_b128 v[38:41], v252 offset:13312
    s_waitcnt lgkmcnt(4)
    v_add_f32 v56, 1.0, v56
    v_mfma_f32_16x16x32_bf16 v[2:5], v[130:133], v[18:21], v[2:5]
    v_rcp_f32 v50, v50
    v_mfma_f32_16x16x32_bf16 v[6:9], v[134:137], v[18:21], v[6:9]
    ds_read_b128 v[42:45], v252 offset:16384
    ds_read_b64 v[214:215], v246 offset:256
    v_add_f32 v57, 1.0, v57
    v_mfma_f32_16x16x32_bf16 v[2:5], v[138:141], v[22:25], v[2:5]
    v_rcp_f32 v51, v51
    v_mfma_f32_16x16x32_bf16 v[6:9], v[142:145], v[22:25], v[6:9]
    ds_read_b128 v[46:49], v252 offset:17408
    s_waitcnt lgkmcnt(4)
    v_mfma_f32_16x16x32_bf16 v[2:5], v[146:149], v[26:29], v[2:5]
    s_waitcnt vmcnt(10)
    s_cmp_eq_u32 s101, 0
    s_cbranch_scc1 L_slow_32
    buffer_store_dword v254, v241, s[4:7], 0 offen offset:1024
    s_branch L_st_33
L_slow_32:
    buffer_store_dword v254, v241, s[4:7], 0 offen offset:1024 sc1
L_st_33:
    v_rcp_f32 v52, v52
    v_mfma_f32_16x16x32_bf16 v[6:9], v[150:153], v[26:29], v[6:9]
    ds_read_b128 v[18:21], v252 offset:18432
    v_mfma_f32_16x16x32_bf16 v[2:5], v[154:157], v[30:33], v[2:5]
    v_rcp_f32 v53, v53
    v_mfma_f32_16x16x32_bf16 v[6:9], v[158:161], v[30:33], v[6:9]
    ds_read_b128 v[22:25], v252 offset:19456
    s_waitcnt lgkmcnt(4)
    v_mfma_f32_16x16x32_bf16 v[2:5], v[162:165], v[34:37], v[2:5]
    v_rcp_f32 v54, v54
    v_mfma_f32_16x16x32_bf16 v[6:9], v[166:169], v[34:37], v[6:9]
    ds_read_b128 v[26:29], v252 offset:20480
    v_rcp_f32 v56, v56
    v_mfma_f32_16x16x32_bf16 v[2:5], v[170:173], v[38:41], v[2:5]
    v_rcp_f32 v55, v55
    v_mfma_f32_16x16x32_bf16 v[6:9], v[174:177], v[38:41], v[6:9]
    ds_read_b128 v[30:33], v252 offset:21504
    s_waitcnt lgkmcnt(4)
    v_rcp_f32 v57, v57
    v_pk_mul_f32 v[50:51], v[50:51], v[10:11]
    v_pk_mul_f32 v[52:53], v[52:53], v[12:13]
    v_pk_mul_f32 v[54:55], v[54:55], v[14:15]
    v_pk_mul_f32 v[56:57], v[56:57], v[16:17]
    v_cvt_pk_bf16_f32 v62, v50, v51
    v_cvt_pk_bf16_f32 v63, v52, v53
    v_cvt_pk_bf16_f32 v64, v54, v55
    v_cvt_pk_bf16_f32 v65, v56, v57
    s_add_u32 s24, s32, 286720
    buffer_store_dwordx4 v[62:65], v1, s[4:7], s24 offen sc1
    v_pk_fma_f32 v[2:3], v[178:179], v[214:215], v[2:3] op_sel_hi:[1,0,1] neg_lo:[0,1,0] neg_hi:[0,1,0]
    v_pk_fma_f32 v[4:5], v[180:181], v[214:215], v[4:5] op_sel_hi:[1,0,1] neg_lo:[0,1,0] neg_hi:[0,1,0]
    v_pk_fma_f32 v[6:7], v[182:183], v[214:215], v[6:7] op_sel_hi:[1,0,1] neg_lo:[0,1,0] neg_hi:[0,1,0]
    v_pk_fma_f32 v[8:9], v[184:185], v[214:215], v[8:9] op_sel_hi:[1,0,1] neg_lo:[0,1,0] neg_hi:[0,1,0]
    v_pk_fma_f32 v[2:3], v[2:3], v[214:215], v[186:187] op_sel:[0,1,0] op_sel_hi:[1,1,1]
    v_pk_fma_f32 v[4:5], v[4:5], v[214:215], v[188:189] op_sel:[0,1,0] op_sel_hi:[1,1,1]
    v_pk_fma_f32 v[6:7], v[6:7], v[214:215], v[190:191] op_sel:[0,1,0] op_sel_hi:[1,1,1]
    v_pk_fma_f32 v[8:9], v[8:9], v[214:215], v[192:193] op_sel:[0,1,0] op_sel_hi:[1,1,1]
    v_pk_mul_f32 v[50:51], v[2:3], v[2:3]
    v_pk_mul_f32 v[52:53], v[4:5], v[4:5]
    v_pk_mul_f32 v[54:55], v[6:7], v[6:7]
    v_pk_mul_f32 v[56:57], v[8:9], v[8:9]
    v_pk_fma_f32 v[50:51], v[50:51], s[34:35], v[218:219]
    v_pk_fma_f32 v[52:53], v[52:53], s[34:35], v[218:219]
    v_pk_fma_f32 v[54:55], v[54:55], s[34:35], v[218:219]
    v_pk_fma_f32 v[56:57], v[56:57], s[34:35], v[218:219]
    v_pk_mul_f32 v[50:51], v[50:51], v[2:3]
    v_pk_mul_f32 v[52:53], v[52:53], v[4:5]
    v_pk_mul_f32 v[54:55], v[54:55], v[6:7]
    v_pk_mul_f32 v[56:57], v[56:57], v[8:9]
    v_mfma_f32_16x16x32_bf16 v[10:13], v[66:69], v[42:45], 0
    s_add_u32 s36, s20, 100352
    s_add_u32 m0, s21, 49152
    v_exp_f32 v50, v50
    v_mfma_f32_16x16x32_bf16 v[14:17], v[70:73], v[42:45], 0
    ds_read_b128 v[34:37], v252 offset:22528
    v_mfma_f32_16x16x32_bf16 v[10:13], v[74:77], v[46:49], v[10:13]
    buffer_load_dwordx4 v1, s[4:7], s36 offen offset:0 sc1 lds
    v_exp_f32 v51, v51
    v_mfma_f32_16x16x32_bf16 v[14:17], v[78:81], v[46:49], v[14:17]
    ds_read_b128 v[38:41], v252 offset:23552
    s_waitcnt lgkmcnt(4)
    v_add_f32 v50, 1.0, v50
    v_mfma_f32_16x16x32_bf16 v[10:13], v[82:85], v[18:21], v[10:13]
    buffer_load_dwordx4 v1, s[4:7], s36 offen offset:1024 sc1 lds
    v_exp_f32 v52, v52
    v_mfma_f32_16x16x32_bf16 v[14:17], v[86:89], v[18:21], v[14:17]
    ds_read_b128 v[42:45], v252 offset:24576
    v_add_f32 v51, 1.0, v51
    v_mfma_f32_16x16x32_bf16 v[10:13], v[90:93], v[22:25], v[10:13]
    buffer_load_dwordx4 v1, s[4:7], s36 offen offset:2048 sc1 lds
    v_exp_f32 v53, v53
    v_mfma_f32_16x16x32_bf16 v[14:17], v[94:97], v[22:25], v[14:17]
    ds_read_b128 v[46:49], v252 offset:25600
    s_waitcnt lgkmcnt(4)
    v_add_f32 v52, 1.0, v52
    v_mfma_f32_16x16x32_bf16 v[10:13], v[98:101], v[26:29], v[10:13]
    buffer_load_dwordx4 v1, s[4:7], s36 offen offset:3072 sc1 lds
    v_exp_f32 v54, v54
    v_mfma_f32_16x16x32_bf16 v[14:17], v[102:105], v[26:29], v[14:17]
    ds_read_b128 v[18:21], v252 offset:26624
    v_add_f32 v53, 1.0, v53
    v_mfma_f32_16x16x32_bf16 v[10:13], v[106:109], v[30:33], v[10:13]
    v_exp_f32 v55, v55
    v_mfma_f32_16x16x32_bf16 v[14:17], v[110:113], v[30:33], v[14:17]
    ds_read_b128 v[22:25], v252 offset:27648
    s_waitcnt lgkmcnt(4)
    v_add_f32 v54, 1.0, v54
    v_mfma_f32_16x16x32_bf16 v[10:13], v[114:117], v[34:37], v[10:13]
    v_exp_f32 v56, v56
    v_mfma_f32_16x16x32_bf16 v[14:17], v[118:121], v[34:37], v[14:17]
    ds_read_b128 v[26:29], v252 offset:28672
    v_add_f32 v55, 1.0, v55
    v_mfma_f32_16x16x32_bf16 v[10:13], v[122:125], v[38:41], v[10:13]
    s_waitcnt vmcnt(6)
    s_barrier
    v_exp_f32 v57, v57
    v_mfma_f32_16x16x32_bf16 v[14:17], v[126:129], v[38:41], v[14:17]
    ds_read_b128 v[30:33], v252 offset:29696
    s_waitcnt lgkmcnt(4)
    v_add_f32 v56, 1.0, v56
    v_mfma_f32_16x16x32_bf16 v[10:13], v[130:133], v[42:45], v[10:13]
    v_rcp_f32 v50, v50
    v_mfma_f32_16x16x32_bf16 v[14:17], v[134:137], v[42:45], v[14:17]
    ds_read_b128 v[34:37], v252 offset:32768
    ds_read_b64 v[216:217], v246 offset:768
    v_add_f32 v57, 1.0, v57
    v_mfma_f32_16x16x32_bf16 v[10:13], v[138:141], v[46:49], v[10:13]
    v_rcp_f32 v51, v51
    v_mfma_f32_16x16x32_bf16 v[14:17], v[142:145], v[46:49], v[14:17]
    ds_read_b128 v[38:41], v252 offset:33792
    s_waitcnt lgkmcnt(4)
    v_mfma_f32_16x16x32_bf16 v[10:13], v[146:149], v[18:21], v[10:13]
    s_waitcnt vmcnt(10)
    s_cmp_eq_u32 s101, 0
    s_cbranch_scc1 L_slow_34
    buffer_store_dword v254, v241, s[4:7], 0 offen offset:256
    s_branch L_st_35
L_slow_34:
    buffer_store_dword v254, v241, s[4:7], 0 offen offset:256 sc1
L_st_35:
    v_rcp_f32 v52, v52
    v_mfma_f32_16x16x32_bf16 v[14:17], v[150:153], v[18:21], v[14:17]
    ds_read_b128 v[42:45], v252 offset:34816
    v_mfma_f32_16x16x32_bf16 v[10:13], v[154:157], v[22:25], v[10:13]
    s_mov_b64 exec, s[30:31]
    buffer_load_dword v244, v243, s[4:7], 0 offen offset:0 sc1
    s_mov_b64 exec, -1
    v_rcp_f32 v53, v53
    v_mfma_f32_16x16x32_bf16 v[14:17], v[158:161], v[22:25], v[14:17]
    ds_read_b128 v[46:49], v252 offset:35840
    s_waitcnt lgkmcnt(4)
    v_mfma_f32_16x16x32_bf16 v[10:13], v[162:165], v[26:29], v[10:13]
    v_rcp_f32 v54, v54
    v_mfma_f32_16x16x32_bf16 v[14:17], v[166:169], v[26:29], v[14:17]
    ds_read_b128 v[18:21], v252 offset:36864
    v_rcp_f32 v56, v56
    v_mfma_f32_16x16x32_bf16 v[10:13], v[170:173], v[30:33], v[10:13]
    v_rcp_f32 v55, v55
    v_mfma_f32_16x16x32_bf16 v[14:17], v[174:177], v[30:33], v[14:17]
    ds_read_b128 v[22:25], v252 offset:37888
    s_waitcnt lgkmcnt(4)
    v_rcp_f32 v57, v57
    v_pk_mul_f32 v[50:51], v[50:51], v[2:3]
    v_pk_mul_f32 v[52:53], v[52:53], v[4:5]
    v_pk_mul_f32 v[54:55], v[54:55], v[6:7]
    v_pk_mul_f32 v[56:57], v[56:57], v[8:9]
    v_cvt_pk_bf16_f32 v58, v50, v51
    v_cvt_pk_bf16_f32 v59, v52, v53
    v_cvt_pk_bf16_f32 v60, v54, v55
    v_cvt_pk_bf16_f32 v61, v56, v57
    s_add_u32 s24, s32, 114688
    buffer_store_dwordx4 v[58:61], v1, s[4:7], s24 offen sc1
    v_pk_fma_f32 v[10:11], v[178:179], v[216:217], v[10:11] op_sel_hi:[1,0,1] neg_lo:[0,1,0] neg_hi:[0,1,0]
    v_pk_fma_f32 v[12:13], v[180:181], v[216:217], v[12:13] op_sel_hi:[1,0,1] neg_lo:[0,1,0] neg_hi:[0,1,0]
    v_pk_fma_f32 v[14:15], v[182:183], v[216:217], v[14:15] op_sel_hi:[1,0,1] neg_lo:[0,1,0] neg_hi:[0,1,0]
    v_pk_fma_f32 v[16:17], v[184:185], v[216:217], v[16:17] op_sel_hi:[1,0,1] neg_lo:[0,1,0] neg_hi:[0,1,0]
    v_pk_fma_f32 v[10:11], v[10:11], v[216:217], v[186:187] op_sel:[0,1,0] op_sel_hi:[1,1,1]
    v_pk_fma_f32 v[12:13], v[12:13], v[216:217], v[188:189] op_sel:[0,1,0] op_sel_hi:[1,1,1]
    v_pk_fma_f32 v[14:15], v[14:15], v[216:217], v[190:191] op_sel:[0,1,0] op_sel_hi:[1,1,1]
    v_pk_fma_f32 v[16:17], v[16:17], v[216:217], v[192:193] op_sel:[0,1,0] op_sel_hi:[1,1,1]
    v_pk_mul_f32 v[50:51], v[10:11], v[10:11]
    v_pk_mul_f32 v[52:53], v[12:13], v[12:13]
    v_pk_mul_f32 v[54:55], v[14:15], v[14:15]
    v_pk_mul_f32 v[56:57], v[16:17], v[16:17]
    v_pk_fma_f32 v[50:51], v[50:51], s[34:35], v[218:219]
    v_pk_fma_f32 v[52:53], v[52:53], s[34:35], v[218:219]
    v_pk_fma_f32 v[54:55], v[54:55], s[34:35], v[218:219]
    v_pk_fma_f32 v[56:57], v[56:57], s[34:35], v[218:219]
    v_pk_mul_f32 v[50:51], v[50:51], v[10:11]
    v_pk_mul_f32 v[52:53], v[52:53], v[12:13]
    v_pk_mul_f32 v[54:55], v[54:55], v[14:15]
    v_pk_mul_f32 v[56:57], v[56:57], v[16:17]
    v_mfma_f32_16x16x32_bf16 v[2:5], v[66:69], v[34:37], 0
    v_exp_f32 v50, v50
    v_mfma_f32_16x16x32_bf16 v[6:9], v[70:73], v[34:37], 0
    ds_read_b128 v[26:29], v252 offset:38912
    v_mfma_f32_16x16x32_bf16 v[2:5], v[74:77], v[38:41], v[2:5]
    s_waitcnt vmcnt(1)
    s_mov_b64 exec, s[30:31]
    v_cmp_ne_u32 vcc, s47, v244
    s_mov_b64 exec, -1
    s_nop 2
    s_cbranch_vccz L_early_36
    s_mov_b64 s[94:95], s[30:31]
    s_mov_b64 exec, s[94:95]
    s_mov_b32 s49, 0
L_poll_37:
    buffer_load_dword v253, v243, s[4:7], 0 offen sc1
    s_waitcnt vmcnt(0)
    v_cmp_ne_u32 vcc, s47, v253
    s_nop 4
    s_cbranch_vccz L_polldone_38
    s_add_u32 s49, s49, 1
    s_cmp_lt_u32 s49, 200000
    s_cbranch_scc1 L_poll_37
    s_add_u32 s99, s99, 1
L_polldone_38:
    s_mov_b64 exec, -1
L_early_36:
    v_exp_f32 v51, v51
    v_mfma_f32_16x16x32_bf16 v[6:9], v[78:81], v[38:41], v[6:9]
    ds_read_b128 v[30:33], v252 offset:39936
    s_waitcnt lgkmcnt(4)
    v_add_f32 v50, 1.0, v50
    v_mfma_f32_16x16x32_bf16 v[2:5], v[82:85], v[42:45], v[2:5]
    buffer_load_dwordx4 v[194:197], v1, s[4:7], s25 offen offset:0 sc1
    v_exp_f32 v52, v52
    v_mfma_f32_16x16x32_bf16 v[6:9], v[86:89], v[42:45], v[6:9]
    ds_read_b128 v[34:37], v252 offset:40960
    v_add_f32 v51, 1.0, v51
    v_mfma_f32_16x16x32_bf16 v[2:5], v[90:93], v[46:49], v[2:5]
    buffer_load_dwordx4 v[198:201], v1, s[4:7], s25 offen offset:1024 sc1
    v_exp_f32 v53, v53
    v_mfma_f32_16x16x32_bf16 v[6:9], v[94:97], v[46:49], v[6:9]
    ds_read_b128 v[38:41], v252 offset:41984
    s_waitcnt lgkmcnt(4)
    v_add_f32 v52, 1.0, v52
    v_mfma_f32_16x16x32_bf16 v[2:5], v[98:101], v[18:21], v[2:5]
    buffer_load_dwordx4 v[202:205], v1, s[4:7], s25 offen offset:2048 sc1
    v_exp_f32 v54, v54
    v_mfma_f32_16x16x32_bf16 v[6:9], v[102:105], v[18:21], v[6:9]
    ds_read_b128 v[42:45], v252 offset:43008
    v_add_f32 v53, 1.0, v53
    v_mfma_f32_16x16x32_bf16 v[2:5], v[106:109], v[22:25], v[2:5]
    v_exp_f32 v55, v55
    v_mfma_f32_16x16x32_bf16 v[6:9], v[110:113], v[22:25], v[6:9]
    ds_read_b128 v[46:49], v252 offset:44032
    s_waitcnt lgkmcnt(4)
    v_add_f32 v54, 1.0, v54
    v_mfma_f32_16x16x32_bf16 v[2:5], v[114:117], v[26:29], v[2:5]
    v_exp_f32 v56, v56
    v_mfma_f32_16x16x32_bf16 v[6:9], v[118:121], v[26:29], v[6:9]
    ds_read_b128 v[18:21], v252 offset:45056
    v_add_f32 v55, 1.0, v55
    v_mfma_f32_16x16x32_bf16 v[2:5], v[122:125], v[30:33], v[2:5]
    s_waitcnt vmcnt(6)
    s_barrier
    v_exp_f32 v57, v57
    v_mfma_f32_16x16x32_bf16 v[6:9], v[126:129], v[30:33], v[6:9]
    ds_read_b128 v[22:25], v252 offset:46080
    s_waitcnt lgkmcnt(4)
    v_add_f32 v56, 1.0, v56
    v_mfma_f32_16x16x32_bf16 v[2:5], v[130:133], v[34:37], v[2:5]
    v_rcp_f32 v50, v50
    v_mfma_f32_16x16x32_bf16 v[6:9], v[134:137], v[34:37], v[6:9]
    ds_read_b128 v[26:29], v252 offset:49152
    ds_read_b64 v[214:215], v246 offset:384
    v_add_f32 v57, 1.0, v57
    v_mfma_f32_16x16x32_bf16 v[2:5], v[138:141], v[38:41], v[2:5]
    v_rcp_f32 v51, v51
    v_mfma_f32_16x16x32_bf16 v[6:9], v[142:145], v[38:41], v[6:9]
    ds_read_b128 v[30:33], v252 offset:50176
    s_waitcnt lgkmcnt(4)
    v_mfma_f32_16x16x32_bf16 v[2:5], v[146:149], v[42:45], v[2:5]
    s_waitcnt vmcnt(10)
    s_cmp_eq_u32 s101, 0
    s_cbranch_scc1 L_slow_39
    buffer_store_dword v254, v241, s[4:7], 0 offen offset:1280
    s_branch L_st_40
L_slow_39:
    buffer_store_dword v254, v241, s[4:7], 0 offen offset:1280 sc1
L_st_40:
    buffer_load_dwordx4 v[206:209], v1, s[4:7], s25 offen offset:3072 sc1
    v_rcp_f32 v52, v52
    v_mfma_f32_16x16x32_bf16 v[6:9], v[150:153], v[42:45], v[6:9]
    ds_read_b128 v[34:37], v252 offset:51200
    v_mfma_f32_16x16x32_bf16 v[2:5], v[154:157], v[46:49], v[2:5]
    buffer_load_dwordx4 v[210:213], v1, s[4:7], s27 offen offset:0 sc1
    v_rcp_f32 v53, v53
    v_mfma_f32_16x16x32_bf16 v[6:9], v[158:161], v[46:49], v[6:9]
    ds_read_b128 v[38:41], v252 offset:52224
    s_waitcnt lgkmcnt(4)
    v_mfma_f32_16x16x32_bf16 v[2:5], v[162:165], v[18:21], v[2:5]
    v_rcp_f32 v54, v54
    v_mfma_f32_16x16x32_bf16 v[6:9], v[166:169], v[18:21], v[6:9]
    ds_read_b128 v[42:45], v252 offset:53248
    v_rcp_f32 v56, v56
    v_mfma_f32_16x16x32_bf16 v[2:5], v[170:173], v[22:25], v[2:5]
    v_rcp_f32 v55, v55
    v_mfma_f32_16x16x32_bf16 v[6:9], v[174:177], v[22:25], v[6:9]
    ds_read_b128 v[46:49], v252 offset:54272
    s_waitcnt lgkmcnt(4)
    v_rcp_f32 v57, v57
    v_pk_mul_f32 v[50:51], v[50:51], v[10:11]
    v_pk_mul_f32 v[52:53], v[52:53], v[12:13]
    v_pk_mul_f32 v[54:55], v[54:55], v[14:15]
    v_pk_mul_f32 v[56:57], v[56:57], v[16:17]
    v_cvt_pk_bf16_f32 v62, v50, v51
    v_cvt_pk_bf16_f32 v63, v52, v53
    v_cvt_pk_bf16_f32 v64, v54, v55
    v_cvt_pk_bf16_f32 v65, v56, v57
    s_add_u32 s24, s32, 344064
    buffer_store_dwordx4 v[62:65], v1, s[4:7], s24 offen sc1
    v_pk_fma_f32 v[2:3], v[178:179], v[214:215], v[2:3] op_sel_hi:[1,0,1] neg_lo:[0,1,0] neg_hi:[0,1,0]
    v_pk_fma_f32 v[4:5], v[180:181], v[214:215], v[4:5] op_sel_hi:[1,0,1] neg_lo:[0,1,0] neg_hi:[0,1,0]
    v_pk_fma_f32 v[6:7], v[182:183], v[214:215], v[6:7] op_sel_hi:[1,0,1] neg_lo:[0,1,0] neg_hi:[0,1,0]
    v_pk_fma_f32 v[8:9], v[184:185], v[214:215], v[8:9] op_sel_hi:[1,0,1] neg_lo:[0,1,0] neg_hi:[0,1,0]
    v_pk_fma_f32 v[2:3], v[2:3], v[214:215], v[186:187] op_sel:[0,1,0] op_sel_hi:[1,1,1]
    v_pk_fma_f32 v[4:5], v[4:5], v[214:215], v[188:189] op_sel:[0,1,0] op_sel_hi:[1,1,1]
    v_pk_fma_f32 v[6:7], v[6:7], v[214:215], v[190:191] op_sel:[0,1,0] op_sel_hi:[1,1,1]
    v_pk_fma_f32 v[8:9], v[8:9], v[214:215], v[192:193] op_sel:[0,1,0] op_sel_hi:[1,1,1]
    v_pk_mul_f32 v[50:51], v[2:3], v[2:3]
    v_pk_mul_f32 v[52:53], v[4:5], v[4:5]
    v_pk_mul_f32 v[54:55], v[6:7], v[6:7]
    v_pk_mul_f32 v[56:57], v[8:9], v[8:9]
    v_pk_fma_f32 v[50:51], v[50:51], s[34:35], v[218:219]
    v_pk_fma_f32 v[52:53], v[52:53], s[34:35], v[218:219]
    v_pk_fma_f32 v[54:55], v[54:55], s[34:35], v[218:219]
    v_pk_fma_f32 v[56:57], v[56:57], s[34:35], v[218:219]
    v_pk_mul_f32 v[50:51], v[50:51], v[2:3]
    v_pk_mul_f32 v[52:53], v[52:53], v[4:5]
    v_pk_mul_f32 v[54:55], v[54:55], v[6:7]
    v_pk_mul_f32 v[56:57], v[56:57], v[8:9]
    v_mfma_f32_16x16x32_bf16 v[10:13], v[66:69], v[26:29], 0
    v_exp_f32 v50, v50
    v_mfma_f32_16x16x32_bf16 v[14:17], v[70:73], v[26:29], 0
    ds_read_b128 v[18:21], v252 offset:55296
    v_mfma_f32_16x16x32_bf16 v[10:13], v[74:77], v[30:33], v[10:13]
    buffer_load_dwordx4 v[220:223], v1, s[4:7], s27 offen offset:1024 sc1
    v_exp_f32 v51, v51
    v_mfma_f32_16x16x32_bf16 v[14:17], v[78:81], v[30:33], v[14:17]
    ds_read_b128 v[22:25], v252 offset:56320
    s_waitcnt lgkmcnt(4)
    v_add_f32 v50, 1.0, v50
    v_mfma_f32_16x16x32_bf16 v[10:13], v[82:85], v[34:37], v[10:13]
    buffer_load_dwordx4 v[224:227], v1, s[4:7], s27 offen offset:2048 sc1
    v_exp_f32 v52, v52
    v_mfma_f32_16x16x32_bf16 v[14:17], v[86:89], v[34:37], v[14:17]
    ds_read_b128 v[26:29], v252 offset:57344
    v_add_f32 v51, 1.0, v51
    v_mfma_f32_16x16x32_bf16 v[10:13], v[90:93], v[38:41], v[10:13]
    buffer_load_dwordx4 v[228:231], v1, s[4:7], s27 offen offset:3072 sc1
    v_exp_f32 v53, v53
    v_mfma_f32_16x16x32_bf16 v[14:17], v[94:97], v[38:41], v[14:17]
    ds_read_b128 v[30:33], v252 offset:58368
    s_waitcnt lgkmcnt(4)
    v_add_f32 v52, 1.0, v52
    v_mfma_f32_16x16x32_bf16 v[10:13], v[98:101], v[42:45], v[10:13]
    buffer_load_dwordx4 v[232:235], v1, s[4:7], s29 offen offset:0 sc1
    v_exp_f32 v54, v54
    v_mfma_f32_16x16x32_bf16 v[14:17], v[102:105], v[42:45], v[14:17]
    ds_read_b128 v[34:37], v252 offset:59392
    v_add_f32 v53, 1.0, v53
    v_mfma_f32_16x16x32_bf16 v[10:13], v[106:109], v[46:49], v[10:13]
    v_exp_f32 v55, v55
    v_mfma_f32_16x16x32_bf16 v[14:17], v[110:113], v[46:49], v[14:17]
    ds_read_b128 v[38:41], v252 offset:60416
    s_waitcnt lgkmcnt(4)
    v_add_f32 v54, 1.0, v54
    v_mfma_f32_16x16x32_bf16 v[10:13], v[114:117], v[18:21], v[10:13]
    v_exp_f32 v56, v56
    v_mfma_f32_16x16x32_bf16 v[14:17], v[118:121], v[18:21], v[14:17]
    ds_read_b128 v[42:45], v252 offset:61440
    v_add_f32 v55, 1.0, v55
    v_mfma_f32_16x16x32_bf16 v[10:13], v[122:125], v[22:25], v[10:13]
    v_exp_f32 v57, v57
    v_mfma_f32_16x16x32_bf16 v[14:17], v[126:129], v[22:25], v[14:17]
    ds_read_b128 v[46:49], v252 offset:62464
    s_waitcnt lgkmcnt(4)
    v_add_f32 v56, 1.0, v56
    v_mfma_f32_16x16x32_bf16 v[10:13], v[130:133], v[26:29], v[10:13]
    v_rcp_f32 v50, v50
    v_mfma_f32_16x16x32_bf16 v[14:17], v[134:137], v[26:29], v[14:17]
    ds_read_b64 v[216:217], v246 offset:896
    v_add_f32 v57, 1.0, v57
    v_mfma_f32_16x16x32_bf16 v[10:13], v[138:141], v[30:33], v[10:13]
    v_rcp_f32 v51, v51
    v_mfma_f32_16x16x32_bf16 v[14:17], v[142:145], v[30:33], v[14:17]
    s_waitcnt lgkmcnt(2)
    v_mfma_f32_16x16x32_bf16 v[10:13], v[146:149], v[34:37], v[10:13]
    s_waitcnt vmcnt(11)
    s_cmp_eq_u32 s101, 0
    s_cbranch_scc1 L_slow_41
    buffer_store_dword v254, v241, s[4:7], 0 offen offset:512
    s_branch L_st_42
L_slow_41:
    buffer_store_dword v254, v241, s[4:7], 0 offen offset:512 sc1
L_st_42:
    v_rcp_f32 v52, v52
    v_mfma_f32_16x16x32_bf16 v[14:17], v[150:153], v[34:37], v[14:17]
    v_mfma_f32_16x16x32_bf16 v[10:13], v[154:157], v[38:41], v[10:13]
    v_rcp_f32 v53, v53
    v_mfma_f32_16x16x32_bf16 v[14:17], v[158:161], v[38:41], v[14:17]
    s_waitcnt lgkmcnt(0)
    v_mfma_f32_16x16x32_bf16 v[10:13], v[162:165], v[42:45], v[10:13]
    v_rcp_f32 v54, v54
    v_mfma_f32_16x16x32_bf16 v[14:17], v[166:169], v[42:45], v[14:17]
    v_rcp_f32 v56, v56
    v_mfma_f32_16x16x32_bf16 v[10:13], v[170:173], v[46:49], v[10:13]
    v_rcp_f32 v55, v55
    v_mfma_f32_16x16x32_bf16 v[14:17], v[174:177], v[46:49], v[14:17]
    v_rcp_f32 v57, v57
    s_branch L_c_done
L_code_end:
.section .rodata,"a"
.p2align 6
.amdhsa_kernel interleave_layers__sliding_local_dilated__mixer_channel_mlp__prompt_kernel
  .amdhsa_next_free_vgpr 512
  .amdhsa_next_free_sgpr 102
  .amdhsa_accum_offset 256
  .amdhsa_group_segment_fixed_size 0
  .amdhsa_kernarg_size 88
  .amdhsa_user_sgpr_count 2
  .amdhsa_user_sgpr_kernarg_segment_ptr 1
  .amdhsa_system_sgpr_workgroup_id_x 1
.end_amdhsa_kernel
```
